```python
import torch

def _softmax(x, axis=-1):
    return torch.softmax(x, dim=axis)
def _gelu(x):
    return torch.nn.functional.gelu(x, approximate="tanh")
def _silu(x):
    return torch.nn.functional.silu(x)
def _sigmoid(x):
    return torch.sigmoid(x)
def _layernorm(x, axis=-1, eps=1e-5):
    m = x.mean(dim=axis, keepdim=True)
    v = x.var(dim=axis, keepdim=True, unbiased=False)
    return (x - m) / torch.sqrt(v + eps)
def _scatter_add(tgt, idx, src, axis=0):
    return tgt.clone().index_add_(axis, idx, src)
def _segment_sum(src, seg, n):
    out = torch.zeros((n,) + src.shape[1:], dtype=src.dtype)
    return out.index_add_(0, seg, src)
def _pad(x, pw):
    flat = tuple(v for pair in reversed(pw) for v in pair)
    return torch.nn.functional.pad(x, flat)

kernel_name = 'standalone__convnext_block__vision'

def setup_inputs():

    _w = (lambda a: (lambda t: t.to(torch.bfloat16) if t.is_floating_point() else t)(torch.as_tensor(a)))
    H = W = 224
    C = 96
    return {
        "x": _w((lambda *s: torch.randn(*s, dtype=torch.bfloat16) * 0.05)(1, H, W, C)),
        "dw": _w((lambda *s: torch.randn(*s, dtype=torch.bfloat16) * 0.05)(7, 7, C)),
        "w1": _w((lambda *s: torch.randn(*s, dtype=torch.bfloat16) * 0.05)(C, 4 * C)),
        "w2": _w((lambda *s: torch.randn(*s, dtype=torch.bfloat16) * 0.05)(4 * C, C)),
    }

def reference(x, dw, w1, w2):
    B, H, W, C = x.shape
    pad = 3
    xp = _pad(x, ((0,0),(pad,pad),(pad,pad),(0,0)))
    out = torch.zeros_like(x)
    for i in range(7):
        for j in range(7):
            out = out + xp[:, i:i+H, j:j+W, :] * dw[i, j][None, None, None, :]
    h = _layernorm(out, axis=-1)
    return x + _gelu(h @ w1) @ w2
```

```asm
; @launch grid=(256,1,1) block=(256,1,1) lds=163840
.amdgcn_target "amdgcn-amd-amdhsa--gfx950"
.text
.globl standalone__convnext_block__vision_kernel
.p2align 12
.p2align 8
.type standalone__convnext_block__vision_kernel,@function
standalone__convnext_block__vision_kernel:
    s_cmp_ge_u32 s2, 256
    s_cbranch_scc1 L_end
    s_load_dwordx2 s[8:9], s[0:1], 8
    s_load_dwordx2 s[4:5], s[0:1], 0
    s_load_dwordx4 s[12:15], s[0:1], 16
    s_load_dwordx2 s[20:21], s[0:1], 32
    s_getpc_b64 s[64:65]
L_pc:
    s_mov_b32 s66, L_tab_end-L_pc
    s_mov_b32 s67, 0x00020000
    s_lshr_b32 s32, s2, 3
    s_mul_i32 s32, s32, 1536
    v_lshlrev_b32 v2, 7, v0
    v_mov_b32 v3, 1073741824
    v_cmp_gt_u32 vcc, 12, v0
    s_nop 1
    v_cndmask_b32 v2, v3, v2, vcc
    buffer_load_dword v46, v2, s[64:67], s32 offen
    v_lshlrev_b32 v47, 4, v0
    s_mov_b32 s16, L_tab-L_pc+0
    buffer_load_dwordx4 v[240:243], v47, s[64:67], s16 offen
    s_mov_b32 s16, L_tab-L_pc+4096
    buffer_load_dwordx4 v[244:247], v47, s[64:67], s16 offen
    s_mov_b32 s16, L_tab-L_pc+20480
    buffer_load_dwordx4 v[4:7], v47, s[64:67], s16 offen
    s_mov_b32 s16, L_tab-L_pc+8192
    buffer_load_dwordx4 v[248:251], v47, s[64:67], s16 offen
    s_mov_b32 s16, L_tab-L_pc+12288
    buffer_load_dwordx4 v[252:255], v47, s[64:67], s16 offen
    s_mov_b32 s16, L_tab-L_pc+16384
    buffer_load_dwordx4 v[8:11], v47, s[64:67], s16 offen
    v_lshrrev_b32 v2, 6, v0
    v_and_b32 v1, 63, v0
    v_readfirstlane_b32 s28, v2
    s_mov_b32 s10, 9408
    s_mov_b32 s11, 0x00020000
    s_mul_i32 s36, s28, 48
    v_lshlrev_b32 v22, 4, v1
    v_add_u32 v226, 0, v1
    v_mul_u32_u24 v226, 171, v226
    v_lshrrev_b32 v217, 9, v226
    v_mul_u32_u24 v226, 144, v217
    v_add3_u32 v214, v226, v22, s36
    v_add_u32 v226, 64, v1
    v_mul_u32_u24 v226, 171, v226
    v_lshrrev_b32 v218, 9, v226
    v_mul_u32_u24 v226, 144, v218
    v_add3_u32 v215, v226, v22, s36
    v_add_u32 v226, 128, v1
    v_mul_u32_u24 v226, 171, v226
    v_lshrrev_b32 v219, 9, v226
    v_mul_u32_u24 v226, 144, v219
    v_add3_u32 v216, v226, v22, s36
    s_and_b32 s32, s2, 7
    s_lshr_b32 s33, s2, 3
    s_lshr_b32 s34, s32, 1
    s_lshl_b32 s34, s34, 2
    s_lshr_b32 s35, s33, 3
    s_add_u32 s34, s34, s35
    s_and_b32 s32, s32, 1
    s_lshl_b32 s32, s32, 3
    s_and_b32 s33, s33, 7
    s_add_u32 s32, s32, s33
    s_mul_i32 s29, s34, 14
    s_mul_i32 s30, s32, 14
    s_mov_b32 s6, 9633792
    s_mov_b32 s7, 0x00020000
    s_mov_b32 s22, 9633792
    s_mov_b32 s23, 0x00020000
    v_mul_u32_u24 v239, 43, v1
    v_lshrrev_b32 v239, 9, v239
    v_mul_u32_u24 v238, 12, v239
    v_sub_u32 v238, v1, v238
    s_sub_u32 s32, s30, 3
    v_lshlrev_b32 v228, 2, v239
    v_add_u32 v228, s32, v228
    v_lshlrev_b32 v229, 4, v238
    v_mov_b32 v231, 1073741824
    v_cmp_gt_u32 vcc, 60, v1
    s_movk_i32 s33, 224
    s_movk_i32 s34, 192
    v_cndmask_b32 v228, v231, v228, vcc
    v_add_u32 v230, 0, v228
    v_cmp_gt_u32 vcc, s33, v230
    v_mad_u32_u24 v232, v230, s34, v229
    s_nop 0
    v_cndmask_b32 v16, v231, v232, vcc
    v_add_u32 v230, 1, v228
    v_cmp_gt_u32 vcc, s33, v230
    v_mad_u32_u24 v232, v230, s34, v229
    s_nop 0
    v_cndmask_b32 v17, v231, v232, vcc
    v_add_u32 v230, 2, v228
    v_cmp_gt_u32 vcc, s33, v230
    v_mad_u32_u24 v232, v230, s34, v229
    s_nop 0
    v_cndmask_b32 v18, v231, v232, vcc
    v_add_u32 v230, 3, v228
    v_cmp_gt_u32 vcc, s33, v230
    v_mad_u32_u24 v232, v230, s34, v229
    s_nop 0
    v_cndmask_b32 v19, v231, v232, vcc
    s_mul_i32 s35, s28, 5
    s_add_u32 s35, s35, s29
    s_sub_u32 s35, s35, 3
    s_add_u32 s36, s35, 0
    s_mul_i32 s37, s36, 43008
    s_cmp_lt_u32 s36, 224
    s_cselect_b32 s48, s37, 1073741824
    s_add_u32 s36, s35, 1
    s_mul_i32 s37, s36, 43008
    s_cmp_lt_u32 s36, 224
    s_cselect_b32 s49, s37, 1073741824
    s_add_u32 s36, s35, 2
    s_mul_i32 s37, s36, 43008
    s_cmp_lt_u32 s36, 224
    s_cselect_b32 s50, s37, 1073741824
    s_add_u32 s36, s35, 3
    s_mul_i32 s37, s36, 43008
    s_cmp_lt_u32 s36, 224
    s_cselect_b32 s51, s37, 1073741824
    s_add_u32 s36, s35, 4
    s_mul_i32 s37, s36, 43008
    s_cmp_lt_u32 s36, 224
    s_cselect_b32 s52, s37, 1073741824
    s_mul_i32 s38, s29, 224
    s_add_u32 s38, s38, s30
    s_mul_i32 s38, s38, 192
    s_waitcnt lgkmcnt(0)
    buffer_load_dwordx4 v[184:187], v214, s[8:11], 0 offen offset:0
    buffer_load_dwordx4 v[188:191], v215, s[8:11], 0 offen offset:1024
    buffer_load_dwordx4 v[192:195], v216, s[8:11], 0 offen offset:2048
    s_mov_b32 s54, -1
    s_mov_b32 s55, 0x0fffffff
    s_mov_b32 s56, 0x0007ffff
    s_mov_b32 s57, 0
    s_mov_b32 s60, 0x00ffffff
    s_mov_b32 s61, 0
    s_mov_b32 s44, 0x00ff00ff
    s_mov_b32 s45, 0x00ff00ff
    s_mov_b32 s46, 0x05040100
    s_mov_b32 s47, 0x07060302
    s_and_b32 s31, s28, 1
    s_mul_i32 s62, s28, 6016
    s_add_u32 s62, s62, 101760
    v_add_u32 v233, s62, v22
    v_mov_b32 v208, 0
    v_mov_b32 v209, 0
    buffer_load_dwordx4 v[48:51], v16, s[4:7], s48 offen
    v_mov_b32 v210, 0
    v_mov_b32 v211, 0
    ds_write_b128 v233, v[208:211] offset:0
    ds_write_b128 v233, v[208:211] offset:1024
    ds_write_b128 v233, v[208:211] offset:2048
    ds_write_b128 v233, v[208:211] offset:2480
    v_min_u32 v234, 176, v22
    ds_write_b128 v234, v[208:211] offset:9216
    s_cmp_lt_u32 s28, 2
    s_cselect_b32 s75, 64, 6144
    s_cselect_b32 s37, 12288, 64
    s_movk_i32 s36, 3072
    s_cselect_b32 s36, 36864, s36
    s_mul_i32 s72, s36, s31
    s_add_u32 s73, s72, s37
    s_add_u32 s74, s73, s37
    s_mul_i32 s63, s28, 3072
    s_lshl_b32 s3, s31, 5
    s_xor_b32 s58, s3, 32
    s_lshl_b32 s39, s28, 6
    s_add_u32 s39, s39, s38
    s_add_u32 s39, s39, 302400
    s_cmp_lt_u32 s28, 3
    s_cselect_b32 s39, s39, 1073741824
    s_lshl_b32 s59, s31, 10
    s_add_u32 s59, s59, L_tab-L_pc+24576
    s_mov_b32 s40, 0x409d30fc
    s_mov_b32 s41, 0x409d30fc
    s_mov_b32 s42, 0x3eeff558
    s_mov_b32 s43, 0x3eeff558
    buffer_load_dwordx4 v[52:55], v17, s[4:7], s48 offen
    s_mov_b32 s53, 0xffff0000
    buffer_load_dwordx4 v[56:59], v18, s[4:7], s48 offen
    buffer_load_dwordx4 v[60:63], v19, s[4:7], s48 offen
    s_cmp_lt_u32 s28, 2
    s_cselect_b64 s[68:69], s[12:13], s[14:15]
    s_mov_b32 s70, 73728
    s_mov_b32 s71, 0x00020000
    s_waitcnt vmcnt(12)
    v_mad_u32_u16 v217, v240, 8, 0
    v_mad_u32_u16 v218, v240, 8, 0 op_sel:[1,0,0,0]
    v_mad_u32_u16 v219, v241, 8, 0
    v_mad_u32_u16 v199, v241, 8, 0 op_sel:[1,0,0,0]
    v_mad_u32_u16 v200, v242, 8, 0
    v_mad_u32_u16 v201, v242, 8, 0 op_sel:[1,0,0,0]
    v_mad_u32_u16 v202, v243, 8, 0
    v_mad_u32_u16 v203, v243, 8, 0 op_sel:[1,0,0,0]
    s_waitcnt vmcnt(11)
    v_mad_u32_u16 v38, v244, 8, 0
    v_mad_u32_u16 v39, v244, 8, 0 op_sel:[1,0,0,0]
    v_mad_u32_u16 v40, v245, 8, 0
    v_mad_u32_u16 v41, v245, 8, 0 op_sel:[1,0,0,0]
    v_mad_u32_u16 v42, v246, 8, 0
    v_mad_u32_u16 v43, v246, 8, 0 op_sel:[1,0,0,0]
    v_mad_u32_u16 v44, v247, 8, 0
    v_mad_u32_u16 v45, v247, 8, 0 op_sel:[1,0,0,0]
    s_waitcnt vmcnt(10)
    v_mad_u32_u16 v196, v7, 8, 0 op_sel:[1,0,0,0]
    v_mad_u32_u16 v20, v7, 8, 0
    ds_write_b64 v196, v[208:209] offset:0
    ds_write_b64 v196, v[208:209] offset:48
    ds_write_b64 v196, v[208:209] offset:96
    ds_write_b64 v196, v[208:209] offset:144
    ds_write_b64 v196, v[208:209] offset:192
    ds_write_b64 v196, v[208:209] offset:3840
    ds_write_b64 v196, v[208:209] offset:3888
    ds_write_b64 v196, v[208:209] offset:3936
    ds_write_b64 v196, v[208:209] offset:3984
    ds_write_b64 v196, v[208:209] offset:4032
    s_waitcnt vmcnt(9)
    v_mad_u32_u16 v23, v248, 8, 0
    v_mad_u32_u16 v21, v248, 8, 0 op_sel:[1,0,0,0]
    v_mad_u32_u16 v24, v249, 8, 0
    v_mad_u32_u16 v25, v249, 8, 0 op_sel:[1,0,0,0]
    v_mad_u32_u16 v26, v250, 8, 0
    v_mad_u32_u16 v27, v250, 8, 0 op_sel:[1,0,0,0]
    v_mad_u32_u16 v34, v251, 8, 0
    v_mad_u32_u16 v37, v251, 8, 0 op_sel:[1,0,0,0]
    s_waitcnt vmcnt(8)
    v_mad_u32_u16 v30, v255, 8, s39 op_sel:[1,0,0,0]
    v_mad_u32_u16 v31, v252, 8, 0
    v_mad_u32_u16 v32, v252, 8, 0 op_sel:[1,0,0,0]
    v_mad_u32_u16 v33, v253, 8, 0
    v_mad_u32_u16 v36, v253, 8, 0 op_sel:[1,0,0,0]
    v_mad_u32_u16 v35, v254, 8, 0
    v_mad_u32_u16 v28, v254, 16, s38 op_sel:[1,0,0,0]
    v_mad_u32_u16 v29, v255, 16, s38
    v_cndmask_b32 v30, v231, v30, s[44:45]
    s_waitcnt vmcnt(4)
    ds_write_b128 v217, v[184:187] offset:144
    ds_write_b128 v218, v[188:191] offset:1168
    s_mov_b64 exec, s[56:57]
    ds_write_b128 v219, v[192:195] offset:2192
    s_mov_b64 exec, -1
    buffer_load_dwordx4 v[64:67], v16, s[4:7], s49 offen
    ds_read_b64_tr_b16 v[128:129], v199 offset:16
    ds_read_b64_tr_b16 v[130:131], v199 offset:496
    ds_read_b64_tr_b16 v[132:133], v199 offset:976
    ds_read_b64_tr_b16 v[134:135], v199 offset:1456
    ds_read_b64_tr_b16 v[136:137], v199 offset:1936
    ds_read_b64_tr_b16 v[138:139], v199 offset:2416
    ds_read_b64_tr_b16 v[140:141], v199 offset:2896
    ds_read_b64_tr_b16 v[142:143], v200 offset:16
    ds_read_b64_tr_b16 v[144:145], v200 offset:1456
    ds_read_b64_tr_b16 v[146:147], v199 offset:32
    ds_read_b64_tr_b16 v[148:149], v199 offset:512
    ds_read_b64_tr_b16 v[150:151], v199 offset:992
    ds_read_b64_tr_b16 v[152:153], v199 offset:1472
    ds_read_b64_tr_b16 v[154:155], v199 offset:1952
    ds_read_b64_tr_b16 v[156:157], v199 offset:2432
    ds_read_b64_tr_b16 v[158:159], v199 offset:2912
    ds_read_b64_tr_b16 v[160:161], v200 offset:32
    ds_read_b64_tr_b16 v[162:163], v200 offset:1472
    ds_read_b64_tr_b16 v[164:165], v199 offset:0
    ds_read_b64_tr_b16 v[166:167], v199 offset:480
    ds_read_b64_tr_b16 v[168:169], v199 offset:960
    ds_read_b64_tr_b16 v[170:171], v199 offset:1440
    ds_read_b64_tr_b16 v[172:173], v199 offset:1920
    ds_read_b64_tr_b16 v[174:175], v199 offset:2400
    ds_read_b64_tr_b16 v[176:177], v199 offset:2880
    ds_read_b64_tr_b16 v[178:179], v200 offset:0
    ds_read_b64_tr_b16 v[180:181], v200 offset:1440
    s_mov_b64 exec, s[60:61]
    ds_write_b64 v203, v[208:209] offset:480
    s_mov_b64 exec, -1
    buffer_load_dwordx4 v[68:71], v17, s[4:7], s49 offen
    s_waitcnt lgkmcnt(15)
    ds_write_b64 v201, v[128:129] offset:0
    ds_write_b64 v201, v[130:131] offset:64
    ds_write_b64 v201, v[132:133] offset:128
    ds_write_b64 v201, v[134:135] offset:192
    ds_write_b64 v201, v[136:137] offset:256
    ds_write_b64 v201, v[138:139] offset:320
    ds_write_b64 v201, v[140:141] offset:384
    ds_write_b64 v202, v[142:143] offset:448
    ds_write_b64 v202, v[144:145] offset:464
    buffer_load_dwordx4 v[72:75], v18, s[4:7], s49 offen
    ds_read_b64 a[0:1], v38 offset:0
    ds_read_b64 a[2:3], v39 offset:0
    ds_read_b64 a[4:5], v40 offset:0
    ds_read_b64 a[6:7], v41 offset:0
    ds_read_b64 a[8:9], v42 offset:0
    ds_read_b64 a[10:11], v43 offset:0
    ds_read_b64 a[12:13], v44 offset:0
    ds_read_b64 a[14:15], v45 offset:0
    buffer_load_dwordx4 v[76:79], v19, s[4:7], s49 offen
    ds_read_b64 a[16:17], v38 offset:752
    ds_read_b64 a[18:19], v39 offset:752
    ds_read_b64 a[20:21], v40 offset:752
    ds_read_b64 a[22:23], v41 offset:752
    ds_read_b64 a[24:25], v42 offset:752
    ds_read_b64 a[26:27], v43 offset:752
    ds_read_b64 a[28:29], v44 offset:752
    ds_read_b64 a[30:31], v45 offset:752
    buffer_load_dwordx4 v[80:83], v16, s[4:7], s50 offen
    ds_read_b64 a[32:33], v38 offset:1504
    ds_read_b64 a[34:35], v39 offset:1504
    ds_read_b64 a[36:37], v40 offset:1504
    ds_read_b64 a[38:39], v41 offset:1504
    ds_read_b64 a[40:41], v42 offset:1504
    ds_read_b64 a[42:43], v43 offset:1504
    ds_read_b64 a[44:45], v44 offset:1504
    ds_read_b64 a[46:47], v45 offset:1504
    buffer_load_dwordx4 v[84:87], v17, s[4:7], s50 offen
    ds_read_b64 a[48:49], v38 offset:2256
    ds_read_b64 a[50:51], v39 offset:2256
    ds_read_b64 a[52:53], v40 offset:2256
    ds_read_b64 a[54:55], v41 offset:2256
    ds_read_b64 a[56:57], v42 offset:2256
    ds_read_b64 a[58:59], v43 offset:2256
    ds_read_b64 a[60:61], v44 offset:2256
    ds_read_b64 a[62:63], v45 offset:2256
    buffer_load_dwordx4 v[88:91], v18, s[4:7], s50 offen
    ds_read_b64 a[64:65], v38 offset:3008
    ds_read_b64 a[66:67], v39 offset:3008
    ds_read_b64 a[68:69], v40 offset:3008
    ds_read_b64 a[70:71], v41 offset:3008
    ds_read_b64 a[72:73], v42 offset:3008
    ds_read_b64 a[74:75], v43 offset:3008
    ds_read_b64 a[76:77], v44 offset:3008
    ds_read_b64 a[78:79], v45 offset:3008
    buffer_load_dwordx4 v[92:95], v19, s[4:7], s50 offen
    ds_read_b64 a[80:81], v38 offset:3760
    ds_read_b64 a[82:83], v39 offset:3760
    ds_read_b64 a[84:85], v40 offset:3760
    ds_read_b64 a[86:87], v41 offset:3760
    ds_read_b64 a[88:89], v42 offset:3760
    ds_read_b64 a[90:91], v43 offset:3760
    ds_read_b64 a[92:93], v44 offset:3760
    ds_read_b64 a[94:95], v45 offset:3760
    buffer_load_dwordx4 v[96:99], v16, s[4:7], s51 offen
    ds_read_b64 a[96:97], v38 offset:4512
    ds_read_b64 a[98:99], v39 offset:4512
    ds_read_b64 a[100:101], v40 offset:4512
    ds_read_b64 a[102:103], v41 offset:4512
    ds_read_b64 a[104:105], v42 offset:4512
    ds_read_b64 a[106:107], v43 offset:4512
    ds_read_b64 a[108:109], v44 offset:4512
    ds_read_b64 a[110:111], v45 offset:4512
    buffer_load_dwordx4 v[100:103], v17, s[4:7], s51 offen
    ds_read_b64 a[112:113], v38 offset:5264
    ds_read_b64 a[114:115], v39 offset:5264
    ds_read_b64 a[116:117], v40 offset:5264
    ds_read_b64 a[118:119], v41 offset:5264
    ds_read_b64 a[120:121], v42 offset:5264
    ds_read_b64 a[122:123], v43 offset:5264
    ds_read_b64 a[124:125], v44 offset:5264
    ds_read_b64 a[126:127], v45 offset:5264
    buffer_load_dwordx4 v[104:107], v18, s[4:7], s51 offen
    s_waitcnt lgkmcnt(15)
    ds_write_b64 v201, v[146:147] offset:0
    ds_write_b64 v201, v[148:149] offset:64
    ds_write_b64 v201, v[150:151] offset:128
    ds_write_b64 v201, v[152:153] offset:192
    ds_write_b64 v201, v[154:155] offset:256
    ds_write_b64 v201, v[156:157] offset:320
    ds_write_b64 v201, v[158:159] offset:384
    ds_write_b64 v202, v[160:161] offset:448
    ds_write_b64 v202, v[162:163] offset:464
    s_waitcnt vmcnt(11)
    s_mov_b64 exec, s[54:55]
    v_perm_b32 v184, v52, v48, s46
    v_perm_b32 v185, v60, v56, s46
    v_perm_b32 v186, v52, v48, s47
    v_perm_b32 v187, v60, v56, s47
    ds_write_b64 v20, v[184:185] offset:0
    ds_write_b64 v20, v[186:187] offset:960
    v_perm_b32 v188, v53, v49, s46
    v_perm_b32 v189, v61, v57, s46
    v_perm_b32 v190, v53, v49, s47
    v_perm_b32 v191, v61, v57, s47
    ds_write_b64 v20, v[188:189] offset:1920
    ds_write_b64 v20, v[190:191] offset:2880
    v_perm_b32 v184, v54, v50, s46
    v_perm_b32 v185, v62, v58, s46
    v_perm_b32 v186, v54, v50, s47
    v_perm_b32 v187, v62, v58, s47
    ds_write_b64 v20, v[184:185] offset:3840
    ds_write_b64 v20, v[186:187] offset:4800
    v_perm_b32 v188, v55, v51, s46
    v_perm_b32 v189, v63, v59, s46
    v_perm_b32 v190, v55, v51, s47
    v_perm_b32 v191, v63, v59, s47
    ds_write_b64 v20, v[188:189] offset:5760
    ds_write_b64 v20, v[190:191] offset:6720
    s_mov_b64 exec, -1
    ds_read_b64 a[128:129], v38 offset:0
    ds_read_b64 a[130:131], v39 offset:0
    ds_read_b64 a[132:133], v40 offset:0
    ds_read_b64 a[134:135], v41 offset:0
    ds_read_b64 a[136:137], v42 offset:0
    ds_read_b64 a[138:139], v43 offset:0
    ds_read_b64 a[140:141], v44 offset:0
    ds_read_b64 a[142:143], v45 offset:0
    buffer_load_dwordx4 v[108:111], v19, s[4:7], s51 offen
    ds_read_b64 a[144:145], v38 offset:752
    ds_read_b64 a[146:147], v39 offset:752
    ds_read_b64 a[148:149], v40 offset:752
    ds_read_b64 a[150:151], v41 offset:752
    ds_read_b64 a[152:153], v42 offset:752
    ds_read_b64 a[154:155], v43 offset:752
    ds_read_b64 a[156:157], v44 offset:752
    ds_read_b64 a[158:159], v45 offset:752
    buffer_load_dwordx4 v[112:115], v16, s[4:7], s52 offen
    ds_read_b64 a[160:161], v38 offset:1504
    ds_read_b64 a[162:163], v39 offset:1504
    ds_read_b64 a[164:165], v40 offset:1504
    ds_read_b64 a[166:167], v41 offset:1504
    ds_read_b64 a[168:169], v42 offset:1504
    ds_read_b64 a[170:171], v43 offset:1504
    ds_read_b64 a[172:173], v44 offset:1504
    ds_read_b64 a[174:175], v45 offset:1504
    buffer_load_dwordx4 v[116:119], v17, s[4:7], s52 offen
    ds_read_b64 a[176:177], v38 offset:2256
    ds_read_b64 a[178:179], v39 offset:2256
    ds_read_b64 a[180:181], v40 offset:2256
    ds_read_b64 a[182:183], v41 offset:2256
    ds_read_b64 a[184:185], v42 offset:2256
    ds_read_b64 a[186:187], v43 offset:2256
    ds_read_b64 a[188:189], v44 offset:2256
    ds_read_b64 a[190:191], v45 offset:2256
    buffer_load_dwordx4 v[120:123], v18, s[4:7], s52 offen
    s_waitcnt vmcnt(11)
    s_mov_b64 exec, s[54:55]
    v_perm_b32 v48, v68, v64, s46
    v_perm_b32 v49, v76, v72, s46
    v_perm_b32 v50, v68, v64, s47
    v_perm_b32 v51, v76, v72, s47
    ds_write_b64 v20, v[48:49] offset:48
    ds_write_b64 v20, v[50:51] offset:1008
    v_perm_b32 v52, v69, v65, s46
    v_perm_b32 v53, v77, v73, s46
    v_perm_b32 v54, v69, v65, s47
    v_perm_b32 v55, v77, v73, s47
    ds_write_b64 v20, v[52:53] offset:1968
    ds_write_b64 v20, v[54:55] offset:2928
    v_perm_b32 v48, v70, v66, s46
    v_perm_b32 v49, v78, v74, s46
    v_perm_b32 v50, v70, v66, s47
    v_perm_b32 v51, v78, v74, s47
    ds_write_b64 v20, v[48:49] offset:3888
    ds_write_b64 v20, v[50:51] offset:4848
    v_perm_b32 v52, v71, v67, s46
    v_perm_b32 v53, v79, v75, s46
    v_perm_b32 v54, v71, v67, s47
    v_perm_b32 v55, v79, v75, s47
    ds_write_b64 v20, v[52:53] offset:5808
    ds_write_b64 v20, v[54:55] offset:6768
    s_mov_b64 exec, -1
    ds_read_b64 a[192:193], v38 offset:3008
    ds_read_b64 a[194:195], v39 offset:3008
    ds_read_b64 a[196:197], v40 offset:3008
    ds_read_b64 a[198:199], v41 offset:3008
    s_mov_b64 exec, 0
    s_cmp_eq_u32 s28, 0
    s_cbranch_scc1 L_pad0
    s_cmp_eq_u32 s28, 1
    s_cbranch_scc1 L_pad1
    s_cmp_eq_u32 s28, 2
    s_cbranch_scc1 L_pad2
    s_branch L_pad3
L_padret:
    s_mov_b64 exec, -1
    ds_read_b64 a[200:201], v42 offset:3008
    ds_read_b64 a[202:203], v43 offset:3008
    ds_read_b64 a[204:205], v44 offset:3008
    ds_read_b64 a[206:207], v45 offset:3008
    buffer_load_dwordx4 v[124:127], v19, s[4:7], s52 offen
    v_mad_u32_u16 v16, v8, 8, 0
    v_mad_u32_u16 v17, v8, 8, 0 op_sel:[1,0,0,0]
    v_mad_u32_u16 v18, v9, 8, 0
    v_mad_u32_u16 v19, v9, 8, 0 op_sel:[1,0,0,0]
    v_mad_u32_u16 v12, v10, 8, 0
    v_mad_u32_u16 v13, v10, 8, 0 op_sel:[1,0,0,0]
    v_mad_u32_u16 v14, v11, 8, 0
    v_mad_u32_u16 v15, v11, 8, 0 op_sel:[1,0,0,0]
    ds_read_b64 a[208:209], v38 offset:3760
    ds_read_b64 a[210:211], v39 offset:3760
    ds_read_b64 a[212:213], v40 offset:3760
    ds_read_b64 a[214:215], v41 offset:3760
    ds_read_b64 a[216:217], v42 offset:3760
    ds_read_b64 a[218:219], v43 offset:3760
    ds_read_b64 a[220:221], v44 offset:3760
    ds_read_b64 a[222:223], v45 offset:3760
    ds_read_b64 a[224:225], v38 offset:4512
    ds_read_b64 a[226:227], v39 offset:4512
    ds_read_b64 a[228:229], v40 offset:4512
    ds_read_b64 a[230:231], v41 offset:4512
    ds_read_b64 a[232:233], v42 offset:4512
    ds_read_b64 a[234:235], v43 offset:4512
    ds_read_b64 a[236:237], v44 offset:4512
    ds_read_b64 a[238:239], v45 offset:4512
    ds_read_b64 a[240:241], v38 offset:5264
    ds_read_b64 a[242:243], v39 offset:5264
    ds_read_b64 a[244:245], v40 offset:5264
    ds_read_b64 a[246:247], v41 offset:5264
    ds_read_b64 a[248:249], v42 offset:5264
    ds_read_b64 a[250:251], v43 offset:5264
    ds_read_b64 a[252:253], v44 offset:5264
    ds_read_b64 a[254:255], v45 offset:5264
    s_add_u32 m0, s63, 151552
    s_nop 0
    buffer_load_dwordx4 v23, s[68:71], s72 offen lds
    s_add_u32 s72, s72, s75
    ds_write_b64 v201, v[164:165] offset:0
    ds_write_b64 v201, v[166:167] offset:64
    ds_write_b64 v201, v[168:169] offset:128
    ds_write_b64 v201, v[170:171] offset:192
    ds_write_b64 v201, v[172:173] offset:256
    ds_write_b64 v201, v[174:175] offset:320
    ds_write_b64 v201, v[176:177] offset:384
    ds_write_b64 v202, v[178:179] offset:448
    ds_write_b64 v202, v[180:181] offset:464
    s_waitcnt vmcnt(9)
    s_mov_b64 exec, s[54:55]
    v_perm_b32 v48, v84, v80, s46
    v_perm_b32 v49, v92, v88, s46
    v_perm_b32 v50, v84, v80, s47
    v_perm_b32 v51, v92, v88, s47
    ds_write_b64 v20, v[48:49] offset:96
    ds_write_b64 v20, v[50:51] offset:1056
    v_perm_b32 v52, v85, v81, s46
    v_perm_b32 v53, v93, v89, s46
    v_perm_b32 v54, v85, v81, s47
    v_perm_b32 v55, v93, v89, s47
    ds_write_b64 v20, v[52:53] offset:2016
    ds_write_b64 v20, v[54:55] offset:2976
    v_perm_b32 v48, v86, v82, s46
    v_perm_b32 v49, v94, v90, s46
    v_perm_b32 v50, v86, v82, s47
    v_perm_b32 v51, v94, v90, s47
    ds_write_b64 v20, v[48:49] offset:3936
    ds_write_b64 v20, v[50:51] offset:4896
    v_perm_b32 v52, v87, v83, s46
    v_perm_b32 v53, v95, v91, s46
    v_perm_b32 v54, v87, v83, s47
    v_perm_b32 v55, v95, v91, s47
    ds_write_b64 v20, v[52:53] offset:5856
    ds_write_b64 v20, v[54:55] offset:6816
    s_mov_b64 exec, -1
    ds_read_b64 v[128:129], v38 offset:0
    ds_read_b64 v[130:131], v39 offset:0
    ds_read_b64 v[132:133], v40 offset:0
    ds_read_b64 v[134:135], v41 offset:0
    ds_read_b64 v[136:137], v42 offset:0
    ds_read_b64 v[138:139], v43 offset:0
    ds_read_b64 v[140:141], v44 offset:0
    ds_read_b64 v[142:143], v45 offset:0
    s_add_u32 m0, s63, 152576
    s_nop 0
    buffer_load_dwordx4 v23, s[68:71], s73 offen lds
    s_add_u32 s73, s73, s75
    ds_read_b64 v[144:145], v38 offset:752
    ds_read_b64 v[146:147], v39 offset:752
    ds_read_b64 v[148:149], v40 offset:752
    ds_read_b64 v[150:151], v41 offset:752
    ds_read_b64 v[152:153], v42 offset:752
    ds_read_b64 v[154:155], v43 offset:752
    ds_read_b64 v[156:157], v44 offset:752
    ds_read_b64 v[158:159], v45 offset:752
    s_add_u32 m0, s63, 153600
    s_nop 0
    buffer_load_dwordx4 v23, s[68:71], s74 offen lds
    s_add_u32 s74, s74, s75
    ds_read_b64 v[160:161], v38 offset:1504
    ds_read_b64 v[162:163], v39 offset:1504
    ds_read_b64 v[164:165], v40 offset:1504
    ds_read_b64 v[166:167], v41 offset:1504
    ds_read_b64 v[168:169], v42 offset:1504
    ds_read_b64 v[170:171], v43 offset:1504
    ds_read_b64 v[172:173], v44 offset:1504
    ds_read_b64 v[174:175], v45 offset:1504
    s_add_u32 m0, s63, 139264
    s_nop 0
    buffer_load_dwordx4 v23, s[68:71], s72 offen lds
    s_add_u32 s72, s72, s75
    ds_read_b64 v[176:177], v38 offset:2256
    ds_read_b64 v[178:179], v39 offset:2256
    ds_read_b64 v[180:181], v40 offset:2256
    ds_read_b64 v[182:183], v41 offset:2256
    ds_read_b64 v[184:185], v42 offset:2256
    ds_read_b64 v[186:187], v43 offset:2256
    ds_read_b64 v[188:189], v44 offset:2256
    ds_read_b64 v[190:191], v45 offset:2256
    s_add_u32 m0, s63, 140288
    s_nop 0
    buffer_load_dwordx4 v23, s[68:71], s73 offen lds
    s_add_u32 s73, s73, s75
    s_waitcnt vmcnt(9)
    s_mov_b64 exec, s[54:55]
    v_perm_b32 v48, v100, v96, s46
    v_perm_b32 v49, v108, v104, s46
    v_perm_b32 v50, v100, v96, s47
    v_perm_b32 v51, v108, v104, s47
    ds_write_b64 v20, v[48:49] offset:144
    ds_write_b64 v20, v[50:51] offset:1104
    v_perm_b32 v52, v101, v97, s46
    v_perm_b32 v53, v109, v105, s46
    v_perm_b32 v54, v101, v97, s47
    v_perm_b32 v55, v109, v105, s47
    ds_write_b64 v20, v[52:53] offset:2064
    ds_write_b64 v20, v[54:55] offset:3024
    v_perm_b32 v48, v102, v98, s46
    v_perm_b32 v49, v110, v106, s46
    v_perm_b32 v50, v102, v98, s47
    v_perm_b32 v51, v110, v106, s47
    ds_write_b64 v20, v[48:49] offset:3984
    ds_write_b64 v20, v[50:51] offset:4944
    v_perm_b32 v52, v103, v99, s46
    v_perm_b32 v53, v111, v107, s46
    v_perm_b32 v54, v103, v99, s47
    v_perm_b32 v55, v111, v107, s47
    ds_write_b64 v20, v[52:53] offset:5904
    ds_write_b64 v20, v[54:55] offset:6864
    s_mov_b64 exec, -1
    ds_read_b64 v[192:193], v38 offset:3008
    ds_read_b64 v[194:195], v39 offset:3008
    ds_read_b64 v[196:197], v40 offset:3008
    ds_read_b64 v[198:199], v41 offset:3008
    ds_read_b64 v[200:201], v42 offset:3008
    ds_read_b64 v[202:203], v43 offset:3008
    ds_read_b64 v[204:205], v44 offset:3008
    ds_read_b64 v[206:207], v45 offset:3008
    s_add_u32 m0, s63, 141312
    s_nop 0
    buffer_load_dwordx4 v23, s[68:71], s74 offen lds
    s_add_u32 s74, s74, s75
    ds_read_b64 v[208:209], v38 offset:3760
    ds_read_b64 v[210:211], v39 offset:3760
    ds_read_b64 v[212:213], v40 offset:3760
    ds_read_b64 v[214:215], v41 offset:3760
    ds_read_b64 v[216:217], v42 offset:3760
    ds_read_b64 v[218:219], v43 offset:3760
    ds_read_b64 v[220:221], v44 offset:3760
    ds_read_b64 v[222:223], v45 offset:3760
    s_add_u32 m0, s63, 126976
    s_nop 0
    buffer_load_dwordx4 v23, s[68:71], s72 offen lds
    s_add_u32 s72, s72, s75
    ds_read_b64 v[224:225], v38 offset:4512
    ds_read_b64 v[226:227], v39 offset:4512
    ds_read_b64 v[228:229], v40 offset:4512
    ds_read_b64 v[230:231], v41 offset:4512
    ds_read_b64 v[232:233], v42 offset:4512
    ds_read_b64 v[234:235], v43 offset:4512
    ds_read_b64 v[236:237], v44 offset:4512
    ds_read_b64 v[238:239], v45 offset:4512
    s_add_u32 m0, s63, 128000
    s_nop 0
    buffer_load_dwordx4 v23, s[68:71], s73 offen lds
    s_add_u32 s73, s73, s75
    ds_read_b64 v[240:241], v38 offset:5264
    ds_read_b64 v[242:243], v39 offset:5264
    ds_read_b64 v[244:245], v40 offset:5264
    ds_read_b64 v[246:247], v41 offset:5264
    ds_read_b64 v[248:249], v42 offset:5264
    ds_read_b64 v[250:251], v43 offset:5264
    ds_read_b64 v[252:253], v44 offset:5264
    ds_read_b64 v[254:255], v45 offset:5264
    s_add_u32 m0, s63, 129024
    s_nop 0
    buffer_load_dwordx4 v23, s[68:71], s74 offen lds
    s_add_u32 s74, s74, s75
    s_mov_b64 exec, s[54:55]
    s_waitcnt vmcnt(9)
    v_perm_b32 v48, v116, v112, s46
    v_perm_b32 v49, v124, v120, s46
    v_perm_b32 v50, v116, v112, s47
    v_perm_b32 v51, v124, v120, s47
    ds_write_b64 v20, v[48:49] offset:192
    ds_write_b64 v20, v[50:51] offset:1152
    v_perm_b32 v52, v117, v113, s46
    v_perm_b32 v53, v125, v121, s46
    v_perm_b32 v54, v117, v113, s47
    v_perm_b32 v55, v125, v121, s47
    ds_write_b64 v20, v[52:53] offset:2112
    ds_write_b64 v20, v[54:55] offset:3072
    v_perm_b32 v48, v118, v114, s46
    v_perm_b32 v49, v126, v122, s46
    v_perm_b32 v50, v118, v114, s47
    v_perm_b32 v51, v126, v122, s47
    ds_write_b64 v20, v[48:49] offset:4032
    ds_write_b64 v20, v[50:51] offset:4992
    v_perm_b32 v52, v119, v115, s46
    v_perm_b32 v53, v127, v123, s46
    v_perm_b32 v54, v119, v115, s47
    v_perm_b32 v55, v127, v123, s47
    ds_write_b64 v20, v[52:53] offset:5952
    ds_write_b64 v20, v[54:55] offset:6912
    s_mov_b64 exec, -1
    v_mov_b32 v38, 0
    v_mov_b32 v39, 0
    v_mov_b32 v40, 0
    v_mov_b32 v41, 0
    v_mov_b32 v42, 0
    v_mov_b32 v43, 0
    v_mov_b32 v44, 0
    v_mov_b32 v45, 0
    s_waitcnt lgkmcnt(0)
    s_barrier
    ds_read_b128 v[96:99], v21 offset:0
    ds_read_b128 v[100:103], v21 offset:48
    ds_read_b128 v[104:107], v21 offset:192
    ds_read_b128 v[108:111], v21 offset:240
    ds_read_b128 v[112:115], v21 offset:960
    ds_read_b128 v[116:119], v21 offset:1008
    ds_read_b128 v[120:123], v21 offset:1152
    ds_read_b128 v[124:127], v21 offset:1200
    s_waitcnt lgkmcnt(4)
    v_mfma_f32_16x16x32_bf16 v[48:51], v[128:131], v[96:99], 0
    ds_read_b128 v[128:131], v21 offset:1920
    v_mfma_f32_16x16x32_bf16 v[48:51], v[132:135], v[100:103], v[48:51]
    ds_read_b128 v[132:135], v21 offset:1968
    v_mfma_f32_16x16x32_bf16 v[48:51], v[136:139], v[104:107], v[48:51]
    ds_read_b128 v[136:139], v21 offset:2112
    v_mfma_f32_16x16x32_bf16 v[48:51], v[140:143], v[108:111], v[48:51]
    ds_read_b128 v[140:143], v21 offset:2160
    s_waitcnt lgkmcnt(4)
    v_mfma_f32_16x16x32_bf16 v[52:55], v[144:147], v[112:115], 0
    ds_read_b128 v[96:99], v21 offset:2880
    v_mfma_f32_16x16x32_bf16 v[52:55], v[148:151], v[116:119], v[52:55]
    s_add_u32 m0, s63, 114688
    ds_read_b128 v[100:103], v21 offset:2928
    v_mfma_f32_16x16x32_bf16 v[52:55], v[152:155], v[120:123], v[52:55]
    ds_read_b128 v[104:107], v21 offset:3072
    buffer_load_dwordx4 v23, s[68:71], s72 offen lds
    v_mfma_f32_16x16x32_bf16 v[52:55], v[156:159], v[124:127], v[52:55]
    s_add_u32 s72, s72, s75
    ds_read_b128 v[108:111], v21 offset:3120
    s_waitcnt lgkmcnt(4)
    v_mfma_f32_16x16x32_bf16 v[56:59], v[160:163], v[128:131], 0
    ds_read_b128 v[112:115], v21 offset:3840
    v_add_f32 v38, v38, v48
    v_mfma_f32_16x16x32_bf16 v[56:59], v[164:167], v[132:135], v[56:59]
    ds_read_b128 v[116:119], v21 offset:3888
    v_add_f32 v39, v39, v49
    v_mfma_f32_16x16x32_bf16 v[56:59], v[168:171], v[136:139], v[56:59]
    ds_read_b128 v[120:123], v21 offset:4032
    v_add_f32 v40, v40, v50
    v_mfma_f32_16x16x32_bf16 v[56:59], v[172:175], v[140:143], v[56:59]
    ds_read_b128 v[124:127], v21 offset:4080
    v_add_f32 v41, v41, v51
    s_waitcnt lgkmcnt(4)
    v_mfma_f32_16x16x32_bf16 v[60:63], v[176:179], v[96:99], 0
    ds_read_b128 v[128:131], v21 offset:4800
    v_add_f32 v38, v38, v52
    v_mfma_f32_16x16x32_bf16 v[60:63], v[180:183], v[100:103], v[60:63]
    ds_read_b128 v[132:135], v21 offset:4848
    v_add_f32 v39, v39, v53
    v_mfma_f32_16x16x32_bf16 v[60:63], v[184:187], v[104:107], v[60:63]
    ds_read_b128 v[136:139], v21 offset:4992
    v_add_f32 v40, v40, v54
    v_mfma_f32_16x16x32_bf16 v[60:63], v[188:191], v[108:111], v[60:63]
    ds_read_b128 v[140:143], v21 offset:5040
    v_add_f32 v41, v41, v55
    s_waitcnt lgkmcnt(4)
    v_mfma_f32_16x16x32_bf16 v[64:67], v[192:195], v[112:115], 0
    ds_read_b128 v[96:99], v21 offset:5760
    v_add_f32 v38, v38, v56
    v_mfma_f32_16x16x32_bf16 v[64:67], v[196:199], v[116:119], v[64:67]
    s_add_u32 m0, s63, 115712
    ds_read_b128 v[100:103], v21 offset:5808
    v_add_f32 v39, v39, v57
    v_mfma_f32_16x16x32_bf16 v[64:67], v[200:203], v[120:123], v[64:67]
    ds_read_b128 v[104:107], v21 offset:5952
    buffer_load_dwordx4 v23, s[68:71], s73 offen lds
    v_add_f32 v40, v40, v58
    v_mfma_f32_16x16x32_bf16 v[64:67], v[204:207], v[124:127], v[64:67]
    s_add_u32 s73, s73, s75
    ds_read_b128 v[108:111], v21 offset:6000
    v_add_f32 v41, v41, v59
    s_waitcnt lgkmcnt(4)
    v_mfma_f32_16x16x32_bf16 v[68:71], v[208:211], v[128:131], 0
    ds_read_b128 v[112:115], v21 offset:6720
    v_add_f32 v38, v38, v60
    v_mfma_f32_16x16x32_bf16 v[68:71], v[212:215], v[132:135], v[68:71]
    ds_read_b128 v[116:119], v21 offset:6768
    v_add_f32 v39, v39, v61
    v_mfma_f32_16x16x32_bf16 v[68:71], v[216:219], v[136:139], v[68:71]
    ds_read_b128 v[120:123], v21 offset:6912
    v_add_f32 v40, v40, v62
    v_mfma_f32_16x16x32_bf16 v[68:71], v[220:223], v[140:143], v[68:71]
    ds_read_b128 v[124:127], v21 offset:6960
    v_add_f32 v41, v41, v63
    s_waitcnt lgkmcnt(4)
    v_mfma_f32_16x16x32_bf16 v[72:75], v[224:227], v[96:99], 0
    ds_read_b128 v[128:131], v21 offset:7696
    v_add_f32 v38, v38, v64
    v_mfma_f32_16x16x32_bf16 v[72:75], v[228:231], v[100:103], v[72:75]
    ds_read_b128 v[132:135], v21 offset:7744
    v_add_f32 v39, v39, v65
    v_mfma_f32_16x16x32_bf16 v[72:75], v[232:235], v[104:107], v[72:75]
    ds_read_b128 v[136:139], v21 offset:7888
    v_add_f32 v40, v40, v66
    v_mfma_f32_16x16x32_bf16 v[72:75], v[236:239], v[108:111], v[72:75]
    ds_read_b128 v[140:143], v21 offset:7936
    v_add_f32 v41, v41, v67
    s_waitcnt lgkmcnt(4)
    v_mfma_f32_16x16x32_bf16 v[76:79], v[240:243], v[112:115], 0
    ds_read_b128 v[96:99], v21 offset:8656
    v_add_f32 v38, v38, v68
    v_mfma_f32_16x16x32_bf16 v[76:79], v[244:247], v[116:119], v[76:79]
    s_add_u32 m0, s63, 116736
    ds_read_b128 v[100:103], v21 offset:8704
    v_add_f32 v39, v39, v69
    v_mfma_f32_16x16x32_bf16 v[76:79], v[248:251], v[120:123], v[76:79]
    ds_read_b128 v[104:107], v21 offset:8848
    buffer_load_dwordx4 v23, s[68:71], s74 offen lds
    v_add_f32 v40, v40, v70
    v_mfma_f32_16x16x32_bf16 v[76:79], v[252:255], v[124:127], v[76:79]
    s_add_u32 s74, s74, s75
    ds_read_b128 v[108:111], v21 offset:8896
    v_add_f32 v41, v41, v71
    s_waitcnt lgkmcnt(4)
    v_mfma_f32_16x16x32_bf16 v[80:83], a[0:3], v[128:131], 0
    ds_read_b128 v[112:115], v21 offset:9616
    v_add_f32 v38, v38, v72
    v_mfma_f32_16x16x32_bf16 v[80:83], a[4:7], v[132:135], v[80:83]
    ds_read_b128 v[116:119], v21 offset:9664
    v_add_f32 v39, v39, v73
    v_mfma_f32_16x16x32_bf16 v[80:83], a[8:11], v[136:139], v[80:83]
    ds_read_b128 v[120:123], v21 offset:9808
    v_add_f32 v40, v40, v74
    v_mfma_f32_16x16x32_bf16 v[80:83], a[12:15], v[140:143], v[80:83]
    ds_read_b128 v[124:127], v21 offset:9856
    v_add_f32 v41, v41, v75
    s_waitcnt lgkmcnt(4)
    v_mfma_f32_16x16x32_bf16 v[84:87], a[16:19], v[96:99], 0
    ds_read_b128 v[128:131], v21 offset:10576
    v_add_f32 v38, v38, v76
    v_mfma_f32_16x16x32_bf16 v[84:87], a[20:23], v[100:103], v[84:87]
    ds_read_b128 v[132:135], v21 offset:10624
    v_add_f32 v39, v39, v77
    v_mfma_f32_16x16x32_bf16 v[84:87], a[24:27], v[104:107], v[84:87]
    ds_read_b128 v[136:139], v21 offset:10768
    v_add_f32 v40, v40, v78
    v_mfma_f32_16x16x32_bf16 v[84:87], a[28:31], v[108:111], v[84:87]
    ds_read_b128 v[140:143], v21 offset:10816
    v_add_f32 v41, v41, v79
    s_waitcnt lgkmcnt(4)
    v_mfma_f32_16x16x32_bf16 v[88:91], a[32:35], v[112:115], 0
    ds_read_b128 v[96:99], v21 offset:11536
    v_add_f32 v38, v38, v80
    v_mfma_f32_16x16x32_bf16 v[88:91], a[36:39], v[116:119], v[88:91]
    s_add_u32 m0, s63, 102400
    ds_read_b128 v[100:103], v21 offset:11584
    v_add_f32 v39, v39, v81
    v_mfma_f32_16x16x32_bf16 v[88:91], a[40:43], v[120:123], v[88:91]
    ds_read_b128 v[104:107], v21 offset:11728
    buffer_load_dwordx4 v23, s[68:71], s72 offen lds
    v_add_f32 v40, v40, v82
    v_mfma_f32_16x16x32_bf16 v[88:91], a[44:47], v[124:127], v[88:91]
    s_add_u32 s72, s72, s75
    ds_read_b128 v[108:111], v21 offset:11776
    v_add_f32 v41, v41, v83
    s_waitcnt lgkmcnt(4)
    v_mfma_f32_16x16x32_bf16 v[92:95], a[48:51], v[128:131], 0
    ds_read_b128 v[112:115], v21 offset:12496
    v_add_f32 v38, v38, v84
    v_mfma_f32_16x16x32_bf16 v[92:95], a[52:55], v[132:135], v[92:95]
    ds_read_b128 v[116:119], v21 offset:12544
    v_add_f32 v39, v39, v85
    v_mfma_f32_16x16x32_bf16 v[92:95], a[56:59], v[136:139], v[92:95]
    ds_read_b128 v[120:123], v21 offset:12688
    v_add_f32 v40, v40, v86
    v_mfma_f32_16x16x32_bf16 v[92:95], a[60:63], v[140:143], v[92:95]
    ds_read_b128 v[124:127], v21 offset:12736
    v_add_f32 v41, v41, v87
    s_waitcnt lgkmcnt(4)
    v_mfma_f32_16x16x32_bf16 v[160:163], a[64:67], v[96:99], 0
    ds_read_b128 v[128:131], v21 offset:13456
    v_add_f32 v38, v38, v88
    v_mfma_f32_16x16x32_bf16 v[160:163], a[68:71], v[100:103], v[160:163]
    ds_read_b128 v[132:135], v21 offset:13504
    v_add_f32 v39, v39, v89
    v_mfma_f32_16x16x32_bf16 v[160:163], a[72:75], v[104:107], v[160:163]
    ds_read_b128 v[136:139], v21 offset:13648
    v_add_f32 v40, v40, v90
    v_mfma_f32_16x16x32_bf16 v[160:163], a[76:79], v[108:111], v[160:163]
    ds_read_b128 v[140:143], v21 offset:13696
    v_add_f32 v41, v41, v91
    s_waitcnt lgkmcnt(4)
    v_mfma_f32_16x16x32_bf16 v[164:167], a[80:83], v[112:115], 0
    ds_read_b128 v[96:99], v21 offset:14416
    v_add_f32 v38, v38, v92
    v_mfma_f32_16x16x32_bf16 v[164:167], a[84:87], v[116:119], v[164:167]
    s_add_u32 m0, s63, 103424
    ds_read_b128 v[100:103], v21 offset:14464
    v_add_f32 v39, v39, v93
    v_mfma_f32_16x16x32_bf16 v[164:167], a[88:91], v[120:123], v[164:167]
    ds_read_b128 v[104:107], v21 offset:14608
    buffer_load_dwordx4 v23, s[68:71], s73 offen lds
    v_add_f32 v40, v40, v94
    v_mfma_f32_16x16x32_bf16 v[164:167], a[92:95], v[124:127], v[164:167]
    s_add_u32 s73, s73, s75
    ds_read_b128 v[108:111], v21 offset:14656
    v_add_f32 v41, v41, v95
    s_waitcnt lgkmcnt(4)
    v_mfma_f32_16x16x32_bf16 v[168:171], a[96:99], v[128:131], 0
    ds_read_b128 v[112:115], v21 offset:15392
    v_add_f32 v38, v38, v160
    v_mfma_f32_16x16x32_bf16 v[168:171], a[100:103], v[132:135], v[168:171]
    ds_read_b128 v[116:119], v21 offset:15440
    v_add_f32 v39, v39, v161
    v_mfma_f32_16x16x32_bf16 v[168:171], a[104:107], v[136:139], v[168:171]
    ds_read_b128 v[120:123], v21 offset:15584
    v_add_f32 v40, v40, v162
    v_mfma_f32_16x16x32_bf16 v[168:171], a[108:111], v[140:143], v[168:171]
    ds_read_b128 v[124:127], v21 offset:15632
    v_add_f32 v41, v41, v163
    s_waitcnt lgkmcnt(4)
    v_mfma_f32_16x16x32_bf16 v[172:175], a[112:115], v[96:99], 0
    ds_read_b128 v[128:131], v21 offset:16352
    v_add_f32 v38, v38, v164
    v_mfma_f32_16x16x32_bf16 v[172:175], a[116:119], v[100:103], v[172:175]
    ds_read_b128 v[132:135], v21 offset:16400
    v_add_f32 v39, v39, v165
    v_mfma_f32_16x16x32_bf16 v[172:175], a[120:123], v[104:107], v[172:175]
    ds_read_b128 v[136:139], v21 offset:16544
    v_add_f32 v40, v40, v166
    v_mfma_f32_16x16x32_bf16 v[172:175], a[124:127], v[108:111], v[172:175]
    ds_read_b128 v[140:143], v21 offset:16592
    v_add_f32 v41, v41, v167
    s_waitcnt lgkmcnt(4)
    v_mfma_f32_16x16x32_bf16 v[176:179], a[128:131], v[112:115], 0
    ds_read_b128 v[96:99], v21 offset:17312
    v_add_f32 v38, v38, v168
    v_mfma_f32_16x16x32_bf16 v[176:179], a[132:135], v[116:119], v[176:179]
    s_add_u32 m0, s63, 104448
    ds_read_b128 v[100:103], v21 offset:17360
    v_add_f32 v39, v39, v169
    v_mfma_f32_16x16x32_bf16 v[176:179], a[136:139], v[120:123], v[176:179]
    ds_read_b128 v[104:107], v21 offset:17504
    buffer_load_dwordx4 v23, s[68:71], s74 offen lds
    v_add_f32 v40, v40, v170
    v_mfma_f32_16x16x32_bf16 v[176:179], a[140:143], v[124:127], v[176:179]
    s_add_u32 s74, s74, s75
    ds_read_b128 v[108:111], v21 offset:17552
    v_add_f32 v41, v41, v171
    s_waitcnt lgkmcnt(4)
    v_mfma_f32_16x16x32_bf16 v[180:183], a[144:147], v[128:131], 0
    ds_read_b128 v[112:115], v21 offset:18272
    v_add_f32 v38, v38, v172
    v_mfma_f32_16x16x32_bf16 v[180:183], a[148:151], v[132:135], v[180:183]
    ds_read_b128 v[116:119], v21 offset:18320
    v_add_f32 v39, v39, v173
    v_mfma_f32_16x16x32_bf16 v[180:183], a[152:155], v[136:139], v[180:183]
    ds_read_b128 v[120:123], v21 offset:18464
    v_add_f32 v40, v40, v174
    v_mfma_f32_16x16x32_bf16 v[180:183], a[156:159], v[140:143], v[180:183]
    ds_read_b128 v[124:127], v21 offset:18512
    v_add_f32 v41, v41, v175
    s_waitcnt lgkmcnt(4)
    v_mfma_f32_16x16x32_bf16 v[184:187], a[160:163], v[96:99], 0
    ds_read_b128 v[128:131], v21 offset:19232
    v_add_f32 v38, v38, v176
    v_mfma_f32_16x16x32_bf16 v[184:187], a[164:167], v[100:103], v[184:187]
    ds_read_b128 v[132:135], v21 offset:19280
    v_add_f32 v39, v39, v177
    v_mfma_f32_16x16x32_bf16 v[184:187], a[168:171], v[104:107], v[184:187]
    ds_read_b128 v[136:139], v21 offset:19424
    v_add_f32 v40, v40, v178
    v_mfma_f32_16x16x32_bf16 v[184:187], a[172:175], v[108:111], v[184:187]
    ds_read_b128 v[140:143], v21 offset:19472
    v_add_f32 v41, v41, v179
    s_waitcnt lgkmcnt(4)
    v_mfma_f32_16x16x32_bf16 v[188:191], a[176:179], v[112:115], 0
    ds_read_b128 v[96:99], v21 offset:20192
    v_add_f32 v38, v38, v180
    v_mfma_f32_16x16x32_bf16 v[188:191], a[180:183], v[116:119], v[188:191]
    ds_read_b128 v[100:103], v21 offset:20240
    v_add_f32 v39, v39, v181
    v_mfma_f32_16x16x32_bf16 v[188:191], a[184:187], v[120:123], v[188:191]
    ds_read_b128 v[104:107], v21 offset:20384
    v_add_f32 v40, v40, v182
    v_mfma_f32_16x16x32_bf16 v[188:191], a[188:191], v[124:127], v[188:191]
    ds_read_b128 v[108:111], v21 offset:20432
    v_add_f32 v41, v41, v183
    s_waitcnt lgkmcnt(4)
    v_mfma_f32_16x16x32_bf16 v[192:195], a[192:195], v[128:131], 0
    ds_read_b128 v[112:115], v21 offset:21152
    v_add_f32 v38, v38, v184
    v_mfma_f32_16x16x32_bf16 v[192:195], a[196:199], v[132:135], v[192:195]
    ds_read_b128 v[116:119], v21 offset:21200
    v_add_f32 v39, v39, v185
    v_mfma_f32_16x16x32_bf16 v[192:195], a[200:203], v[136:139], v[192:195]
    ds_read_b128 v[120:123], v21 offset:21344
    v_add_f32 v40, v40, v186
    v_mfma_f32_16x16x32_bf16 v[192:195], a[204:207], v[140:143], v[192:195]
    ds_read_b128 v[124:127], v21 offset:21392
    v_add_f32 v41, v41, v187
    s_waitcnt lgkmcnt(4)
    v_mfma_f32_16x16x32_bf16 v[196:199], a[208:211], v[96:99], 0
    ds_read_b128 v[128:131], v21 offset:22112
    v_add_f32 v38, v38, v188
    v_mfma_f32_16x16x32_bf16 v[196:199], a[212:215], v[100:103], v[196:199]
    ds_read_b128 v[132:135], v21 offset:22160
    v_add_f32 v39, v39, v189
    v_mfma_f32_16x16x32_bf16 v[196:199], a[216:219], v[104:107], v[196:199]
    ds_read_b128 v[136:139], v21 offset:22304
    v_add_f32 v40, v40, v190
    v_mfma_f32_16x16x32_bf16 v[196:199], a[220:223], v[108:111], v[196:199]
    ds_read_b128 v[140:143], v21 offset:22352
    v_add_f32 v41, v41, v191
    s_waitcnt lgkmcnt(4)
    v_mfma_f32_16x16x32_bf16 v[200:203], a[224:227], v[112:115], 0
    v_add_f32 v38, v38, v192
    v_mfma_f32_16x16x32_bf16 v[200:203], a[228:231], v[116:119], v[200:203]
    v_add_f32 v39, v39, v193
    v_mfma_f32_16x16x32_bf16 v[200:203], a[232:235], v[120:123], v[200:203]
    v_add_f32 v40, v40, v194
    v_mfma_f32_16x16x32_bf16 v[200:203], a[236:239], v[124:127], v[200:203]
    v_add_f32 v41, v41, v195
    s_waitcnt lgkmcnt(0)
    v_mfma_f32_16x16x32_bf16 v[204:207], a[240:243], v[128:131], 0
    v_add_f32 v38, v38, v196
    v_mfma_f32_16x16x32_bf16 v[204:207], a[244:247], v[132:135], v[204:207]
    v_add_f32 v39, v39, v197
    v_mfma_f32_16x16x32_bf16 v[204:207], a[248:251], v[136:139], v[204:207]
    v_add_f32 v40, v40, v198
    v_mfma_f32_16x16x32_bf16 v[204:207], a[252:255], v[140:143], v[204:207]
    v_add_f32 v41, v41, v199
    v_pk_fma_f32 v[42:43], v[48:49], v[48:49], v[42:43]
    v_pk_fma_f32 v[44:45], v[50:51], v[50:51], v[44:45]
    v_pk_fma_f32 v[42:43], v[52:53], v[52:53], v[42:43]
    v_pk_fma_f32 v[44:45], v[54:55], v[54:55], v[44:45]
    v_pk_fma_f32 v[42:43], v[56:57], v[56:57], v[42:43]
    v_pk_fma_f32 v[44:45], v[58:59], v[58:59], v[44:45]
    v_pk_fma_f32 v[42:43], v[60:61], v[60:61], v[42:43]
    v_pk_fma_f32 v[44:45], v[62:63], v[62:63], v[44:45]
    v_pk_fma_f32 v[42:43], v[64:65], v[64:65], v[42:43]
    v_pk_fma_f32 v[44:45], v[66:67], v[66:67], v[44:45]
    v_pk_fma_f32 v[42:43], v[68:69], v[68:69], v[42:43]
    v_pk_fma_f32 v[44:45], v[70:71], v[70:71], v[44:45]
    v_pk_fma_f32 v[42:43], v[72:73], v[72:73], v[42:43]
    v_pk_fma_f32 v[44:45], v[74:75], v[74:75], v[44:45]
    v_pk_fma_f32 v[42:43], v[76:77], v[76:77], v[42:43]
    v_pk_fma_f32 v[44:45], v[78:79], v[78:79], v[44:45]
    v_pk_fma_f32 v[42:43], v[80:81], v[80:81], v[42:43]
    v_pk_fma_f32 v[44:45], v[82:83], v[82:83], v[44:45]
    v_pk_fma_f32 v[42:43], v[84:85], v[84:85], v[42:43]
    v_pk_fma_f32 v[44:45], v[86:87], v[86:87], v[44:45]
    v_pk_fma_f32 v[42:43], v[88:89], v[88:89], v[42:43]
    v_pk_fma_f32 v[44:45], v[90:91], v[90:91], v[44:45]
    v_pk_fma_f32 v[42:43], v[92:93], v[92:93], v[42:43]
    v_pk_fma_f32 v[44:45], v[94:95], v[94:95], v[44:45]
    v_pk_fma_f32 v[42:43], v[160:161], v[160:161], v[42:43]
    v_pk_fma_f32 v[44:45], v[162:163], v[162:163], v[44:45]
    v_pk_fma_f32 v[42:43], v[164:165], v[164:165], v[42:43]
    v_pk_fma_f32 v[44:45], v[166:167], v[166:167], v[44:45]
    v_pk_fma_f32 v[42:43], v[168:169], v[168:169], v[42:43]
    v_pk_fma_f32 v[44:45], v[170:171], v[170:171], v[44:45]
    v_pk_fma_f32 v[42:43], v[172:173], v[172:173], v[42:43]
    v_pk_fma_f32 v[44:45], v[174:175], v[174:175], v[44:45]
    v_pk_fma_f32 v[42:43], v[176:177], v[176:177], v[42:43]
    v_pk_fma_f32 v[44:45], v[178:179], v[178:179], v[44:45]
    v_pk_fma_f32 v[42:43], v[180:181], v[180:181], v[42:43]
    v_pk_fma_f32 v[44:45], v[182:183], v[182:183], v[44:45]
    v_pk_fma_f32 v[42:43], v[184:185], v[184:185], v[42:43]
    v_pk_fma_f32 v[44:45], v[186:187], v[186:187], v[44:45]
    v_pk_fma_f32 v[42:43], v[188:189], v[188:189], v[42:43]
    v_pk_fma_f32 v[44:45], v[190:191], v[190:191], v[44:45]
    v_pk_fma_f32 v[42:43], v[192:193], v[192:193], v[42:43]
    v_pk_fma_f32 v[44:45], v[194:195], v[194:195], v[44:45]
    v_pk_fma_f32 v[42:43], v[196:197], v[196:197], v[42:43]
    v_pk_fma_f32 v[44:45], v[198:199], v[198:199], v[44:45]
    v_pk_fma_f32 v[42:43], v[200:201], v[200:201], v[42:43]
    v_pk_fma_f32 v[44:45], v[202:203], v[202:203], v[44:45]
    v_pk_add_f32 v[38:39], v[38:39], v[200:201]
    v_pk_add_f32 v[40:41], v[40:41], v[202:203]
    v_pk_fma_f32 v[42:43], v[204:205], v[204:205], v[42:43]
    v_pk_fma_f32 v[44:45], v[206:207], v[206:207], v[44:45]
    v_pk_add_f32 v[38:39], v[38:39], v[204:205]
    v_pk_add_f32 v[40:41], v[40:41], v[206:207]
    s_mov_b32 s36, 0x3c2aaaab
    s_mov_b32 s37, 0x3c2aaaab
    s_mov_b32 s34, 0x3727c5ac
    s_mov_b32 s35, 0x3727c5ac
    ds_write_b128 v34, v[38:41]
    ds_write_b128 v34, v[42:45] offset:1024
    s_waitcnt vmcnt(3) lgkmcnt(0)
    s_barrier
    ds_read_b128 v[224:227], v22 offset:0
    ds_read_b128 v[228:231], v22 offset:1024
    ds_read_b128 v[232:235], v22 offset:2048
    ds_read_b128 v[236:239], v22 offset:3072
    ds_read_b128 v[240:243], v22 offset:4096
    ds_read_b128 v[244:247], v22 offset:5120
    ds_read_b128 v[248:251], v22 offset:6144
    ds_read_b128 v[252:255], v22 offset:7168
    v_mad_u32_u16 v40, v4, 16, s38
    v_mad_u32_u16 v41, v4, 16, s38 op_sel:[1,0,0,0]
    v_mad_u32_u16 v42, v5, 16, s38
    v_mad_u32_u16 v43, v5, 16, s38 op_sel:[1,0,0,0]
    v_mad_u32_u16 v38, v6, 8, 0
    v_mad_u32_u16 v39, v6, 8, 0 op_sel:[1,0,0,0]
    s_lshl_b32 s38, s31, 7
    s_lshl_b32 s39, s31, 5
    s_add_u32 s39, s39, 64
    s_mov_b32 vcc_lo, 0x55555555
    s_mov_b32 vcc_hi, 0x55555555
    s_waitcnt lgkmcnt(0)
    v_pk_add_f32 v[224:225], v[224:225], v[232:233]
    v_pk_add_f32 v[240:241], v[240:241], v[248:249]
    v_pk_add_f32 v[226:227], v[226:227], v[234:235]
    v_pk_add_f32 v[242:243], v[242:243], v[250:251]
    v_pk_add_f32 v[228:229], v[228:229], v[236:237]
    v_pk_add_f32 v[244:245], v[244:245], v[252:253]
    v_pk_add_f32 v[230:231], v[230:231], v[238:239]
    v_pk_add_f32 v[246:247], v[246:247], v[254:255]
    v_pk_add_f32 v[224:225], v[224:225], v[240:241]
    ds_read_b64_tr_b16 a[0:1], v16 offset:49152
    v_pk_add_f32 v[226:227], v[226:227], v[242:243]
    ds_read_b64_tr_b16 a[2:3], v16 offset:49408
    v_pk_add_f32 v[228:229], v[228:229], v[244:245]
    ds_read_b64_tr_b16 a[4:5], v16 offset:50176
    v_pk_add_f32 v[230:231], v[230:231], v[246:247]
    ds_read_b64_tr_b16 a[6:7], v16 offset:50432
    v_pk_mul_f32 v[224:225], v[224:225], s[36:37]
    ds_read_b64_tr_b16 a[8:9], v16 offset:51200
    v_pk_mul_f32 v[226:227], v[226:227], s[36:37]
    ds_read_b64_tr_b16 a[10:11], v16 offset:51456
    v_pk_fma_f32 v[240:241], v[224:225], v[224:225], s[34:35] neg_lo:[1,0,0] neg_hi:[1,0,0]
    ds_read_b64_tr_b16 a[12:13], v16 offset:52224
    v_pk_fma_f32 v[242:243], v[226:227], v[226:227], s[34:35] neg_lo:[1,0,0] neg_hi:[1,0,0]
    ds_read_b64_tr_b16 a[14:15], v16 offset:52480
    v_pk_fma_f32 v[240:241], v[228:229], s[36:37], v[240:241]
    ds_read_b64_tr_b16 a[16:17], v16 offset:53248
    v_pk_fma_f32 v[242:243], v[230:231], s[36:37], v[242:243]
    ds_read_b64_tr_b16 a[18:19], v16 offset:53504
    v_max_f32 v240, s34, v240
    ds_read_b64_tr_b16 a[20:21], v16 offset:54272
    v_max_f32 v241, s34, v241
    ds_read_b64_tr_b16 a[22:23], v16 offset:54528
    v_max_f32 v242, s34, v242
    v_max_f32 v243, s34, v243
    v_rsq_f32 v240, v240
    v_rsq_f32 v241, v241
    v_rsq_f32 v242, v242
    v_rsq_f32 v243, v243
    s_nop 0
    v_pk_mul_f32 v[232:233], v[240:241], s[42:43]
    v_pk_mul_f32 v[234:235], v[242:243], s[42:43]
    v_pk_mul_f32 v[236:237], v[224:225], v[232:233] neg_lo:[1,0] neg_hi:[1,0]
    v_pk_mul_f32 v[238:239], v[226:227], v[234:235] neg_lo:[1,0] neg_hi:[1,0]
    v_pk_fma_f32 v[48:49], v[48:49], v[232:233], v[236:237]
    v_pk_fma_f32 v[52:53], v[52:53], v[232:233], v[236:237]
    v_pk_fma_f32 v[56:57], v[56:57], v[232:233], v[236:237]
    v_pk_fma_f32 v[60:61], v[60:61], v[232:233], v[236:237]
    v_pk_fma_f32 v[64:65], v[64:65], v[232:233], v[236:237]
    v_pk_fma_f32 v[68:69], v[68:69], v[232:233], v[236:237]
    v_pk_fma_f32 v[72:73], v[72:73], v[232:233], v[236:237]
    v_pk_fma_f32 v[76:77], v[76:77], v[232:233], v[236:237]
    v_cvt_pk_bf16_f32 v96, v48, v52
    v_cvt_pk_bf16_f32 v97, v56, v60
    v_cvt_pk_bf16_f32 v98, v64, v68
    v_cvt_pk_bf16_f32 v99, v72, v76
    ds_write_b128 v24, v[96:99] offset:0
    v_cvt_pk_bf16_f32 v108, v49, v53
    v_cvt_pk_bf16_f32 v109, v57, v61
    v_cvt_pk_bf16_f32 v110, v65, v69
    v_cvt_pk_bf16_f32 v111, v73, v77
    v_pk_fma_f32 v[50:51], v[50:51], v[234:235], v[238:239]
    v_pk_fma_f32 v[54:55], v[54:55], v[234:235], v[238:239]
    v_pk_fma_f32 v[58:59], v[58:59], v[234:235], v[238:239]
L_pad0:
    s_cbranch_execz L_padret
    v_pk_fma_f32 v[62:63], v[62:63], v[234:235], v[238:239]
    ds_write_b128 v25, v[108:111] offset:0
    v_pk_fma_f32 v[66:67], v[66:67], v[234:235], v[238:239]
    v_pk_fma_f32 v[70:71], v[70:71], v[234:235], v[238:239]
    v_pk_fma_f32 v[74:75], v[74:75], v[234:235], v[238:239]
    v_pk_fma_f32 v[78:79], v[78:79], v[234:235], v[238:239]
    v_cvt_pk_bf16_f32 v120, v50, v54
    v_cvt_pk_bf16_f32 v121, v58, v62
    v_cvt_pk_bf16_f32 v122, v66, v70
    v_cvt_pk_bf16_f32 v123, v74, v78
    ds_write_b128 v26, v[120:123] offset:0
    v_cvt_pk_bf16_f32 v132, v51, v55
    v_cvt_pk_bf16_f32 v133, v59, v63
    v_cvt_pk_bf16_f32 v134, v67, v71
    v_cvt_pk_bf16_f32 v135, v75, v79
    v_pk_fma_f32 v[80:81], v[80:81], v[232:233], v[236:237]
    v_pk_fma_f32 v[84:85], v[84:85], v[232:233], v[236:237]
    v_pk_fma_f32 v[88:89], v[88:89], v[232:233], v[236:237]
    v_pk_fma_f32 v[92:93], v[92:93], v[232:233], v[236:237]
    ds_write_b128 v27, v[132:135] offset:0
    v_pk_fma_f32 v[160:161], v[160:161], v[232:233], v[236:237]
    v_pk_fma_f32 v[164:165], v[164:165], v[232:233], v[236:237]
    v_pk_fma_f32 v[168:169], v[168:169], v[232:233], v[236:237]
    v_pk_fma_f32 v[172:173], v[172:173], v[232:233], v[236:237]
    v_cvt_pk_bf16_f32 v100, v80, v84
    v_cvt_pk_bf16_f32 v101, v88, v92
    v_cvt_pk_bf16_f32 v102, v160, v164
    v_cvt_pk_bf16_f32 v103, v168, v172
    ds_write_b128 v24, v[100:103] offset:16
    v_cvt_pk_bf16_f32 v112, v81, v85
    v_cvt_pk_bf16_f32 v113, v89, v93
    v_cvt_pk_bf16_f32 v114, v161, v165
    v_cvt_pk_bf16_f32 v115, v169, v173
    v_pk_fma_f32 v[82:83], v[82:83], v[234:235], v[238:239]
    v_pk_fma_f32 v[86:87], v[86:87], v[234:235], v[238:239]
    v_pk_fma_f32 v[90:91], v[90:91], v[234:235], v[238:239]
    v_pk_fma_f32 v[94:95], v[94:95], v[234:235], v[238:239]
    ds_write_b128 v25, v[112:115] offset:16
    v_pk_fma_f32 v[162:163], v[162:163], v[234:235], v[238:239]
    v_pk_fma_f32 v[166:167], v[166:167], v[234:235], v[238:239]
    v_pk_fma_f32 v[170:171], v[170:171], v[234:235], v[238:239]
    v_pk_fma_f32 v[174:175], v[174:175], v[234:235], v[238:239]
    v_cvt_pk_bf16_f32 v124, v82, v86
    v_cvt_pk_bf16_f32 v125, v90, v94
    v_cvt_pk_bf16_f32 v126, v162, v166
    v_cvt_pk_bf16_f32 v127, v170, v174
    ds_write_b128 v26, v[124:127] offset:16
    v_cvt_pk_bf16_f32 v136, v83, v87
    v_cvt_pk_bf16_f32 v137, v91, v95
    v_cvt_pk_bf16_f32 v138, v163, v167
    v_cvt_pk_bf16_f32 v139, v171, v175
    v_pk_fma_f32 v[176:177], v[176:177], v[232:233], v[236:237]
    v_pk_fma_f32 v[180:181], v[180:181], v[232:233], v[236:237]
    v_pk_fma_f32 v[184:185], v[184:185], v[232:233], v[236:237]
    v_pk_fma_f32 v[188:189], v[188:189], v[232:233], v[236:237]
    ds_write_b128 v27, v[136:139] offset:16
    v_pk_fma_f32 v[192:193], v[192:193], v[232:233], v[236:237]
    v_pk_fma_f32 v[196:197], v[196:197], v[232:233], v[236:237]
    v_pk_fma_f32 v[200:201], v[200:201], v[232:233], v[236:237]
    v_pk_fma_f32 v[204:205], v[204:205], v[232:233], v[236:237]
    v_cvt_pk_bf16_f32 v104, v176, v180
    v_cvt_pk_bf16_f32 v105, v184, v188
    v_cvt_pk_bf16_f32 v106, v192, v196
    v_cvt_pk_bf16_f32 v107, v200, v204
    s_add_u32 m0, s63, 90112
    ds_write_b128 v24, v[104:107] offset:32
    buffer_load_dwordx4 v23, s[68:71], s72 offen lds
    s_add_u32 s72, s72, s75
    v_cvt_pk_bf16_f32 v116, v177, v181
    v_cvt_pk_bf16_f32 v117, v185, v189
    v_cvt_pk_bf16_f32 v118, v193, v197
    v_cvt_pk_bf16_f32 v119, v201, v205
    v_pk_fma_f32 v[178:179], v[178:179], v[234:235], v[238:239]
    v_pk_fma_f32 v[182:183], v[182:183], v[234:235], v[238:239]
    v_pk_fma_f32 v[186:187], v[186:187], v[234:235], v[238:239]
    v_pk_fma_f32 v[190:191], v[190:191], v[234:235], v[238:239]
    ds_write_b128 v25, v[116:119] offset:32
    v_pk_fma_f32 v[194:195], v[194:195], v[234:235], v[238:239]
    v_pk_fma_f32 v[198:199], v[198:199], v[234:235], v[238:239]
    v_pk_fma_f32 v[202:203], v[202:203], v[234:235], v[238:239]
    v_pk_fma_f32 v[206:207], v[206:207], v[234:235], v[238:239]
    v_cvt_pk_bf16_f32 v128, v178, v182
    v_cvt_pk_bf16_f32 v129, v186, v190
    v_cvt_pk_bf16_f32 v130, v194, v198
    v_cvt_pk_bf16_f32 v131, v202, v206
    s_add_u32 m0, s63, 91136
    ds_write_b128 v26, v[128:131] offset:32
    buffer_load_dwordx4 v23, s[68:71], s73 offen lds
    s_add_u32 s73, s73, s75
    v_cvt_pk_bf16_f32 v140, v179, v183
    v_cvt_pk_bf16_f32 v141, v187, v191
    v_cvt_pk_bf16_f32 v142, v195, v199
    v_cvt_pk_bf16_f32 v143, v203, v207
    ds_write_b128 v27, v[140:143] offset:32
    s_waitcnt lgkmcnt(0)
    s_barrier
    ds_read_b128 a[72:75], v32 offset:0
    ds_read_b128 a[76:79], v32 offset:32
    ds_read_b128 a[80:83], v32 offset:64
    ds_read_b128 a[84:87], v32 offset:96
    ds_read_b128 a[88:91], v32 offset:128
    ds_read_b128 a[92:95], v32 offset:160
    s_add_u32 m0, s63, 92160
    s_nop 0
    buffer_load_dwordx4 v23, s[68:71], s74 offen lds
    s_add_u32 s74, s74, s75
    ds_read_b128 a[48:51], v31 offset:0
    ds_read_b128 a[52:55], v31 offset:32
    s_waitcnt lgkmcnt(7)
    v_mfma_f32_32x32x16_bf16 v[48:63], a[0:3], a[72:75], 0
    ds_read_b128 a[56:59], v31 offset:64
    ds_read_b128 a[60:63], v31 offset:96
    s_waitcnt lgkmcnt(8)
    v_mfma_f32_32x32x16_bf16 v[48:63], a[4:7], a[76:79], v[48:63]
    ds_read_b128 a[64:67], v31 offset:128
    ds_read_b128 a[68:71], v31 offset:160
    s_waitcnt lgkmcnt(9)
    v_mfma_f32_32x32x16_bf16 v[48:63], a[8:11], a[80:83], v[48:63]
    ds_read_b128 a[96:99], v33 offset:0
    ds_read_b128 a[100:103], v33 offset:32
    s_waitcnt lgkmcnt(10)
    v_mfma_f32_32x32x16_bf16 v[48:63], a[12:15], a[84:87], v[48:63]
    ds_read_b128 a[104:107], v33 offset:64
    ds_read_b128 a[108:111], v33 offset:96
    s_waitcnt lgkmcnt(11)
    v_mfma_f32_32x32x16_bf16 v[48:63], a[16:19], a[88:91], v[48:63]
    ds_read_b128 a[112:115], v33 offset:128
    ds_read_b128 a[116:119], v33 offset:160
    s_waitcnt lgkmcnt(12)
    v_mfma_f32_32x32x16_bf16 v[48:63], a[20:23], a[92:95], v[48:63]
    s_waitcnt lgkmcnt(6)
    v_mfma_f32_32x32x16_bf16 v[64:79], a[0:3], a[48:51], 0
    ds_read_b64_tr_b16 a[24:25], v16 offset:55296
    ds_read_b64_tr_b16 a[26:27], v16 offset:55552
    v_mfma_f32_32x32x16_bf16 v[64:79], a[4:7], a[52:55], v[64:79]
    ds_read_b64_tr_b16 a[28:29], v16 offset:56320
    ds_read_b64_tr_b16 a[30:31], v16 offset:56576
    v_mfma_f32_32x32x16_bf16 v[64:79], a[8:11], a[56:59], v[64:79]
    ds_read_b64_tr_b16 a[32:33], v16 offset:57344
    ds_read_b64_tr_b16 a[34:35], v16 offset:57600
    v_fma_f32 v96, v48, v48, s40
    v_fma_f32 v97, v49, v49, s40
    v_fma_f32 v98, v50, v50, s40
    v_fma_f32 v99, v51, v51, s40
    v_fma_f32 v100, v52, v52, s40
    v_fma_f32 v101, v53, v53, s40
    v_mfma_f32_32x32x16_bf16 v[64:79], a[12:15], a[60:63], v[64:79]
    s_add_u32 m0, s63, 77824
    ds_read_b64_tr_b16 a[36:37], v16 offset:58368
    ds_read_b64_tr_b16 a[38:39], v16 offset:58624
    v_fma_f32 v102, v54, v54, s40
    v_fma_f32 v103, v55, v55, s40
    v_fma_f32 v104, v56, v56, s40
    v_fma_f32 v105, v57, v57, s40
    v_fma_f32 v106, v58, v58, s40
    v_mfma_f32_32x32x16_bf16 v[64:79], a[16:19], a[64:67], v[64:79]
    ds_read_b64_tr_b16 a[40:41], v16 offset:59392
    ds_read_b64_tr_b16 a[42:43], v16 offset:59648
    buffer_load_dwordx4 v23, s[68:71], s72 offen lds
    v_fma_f32 v107, v59, v59, s40
    v_fma_f32 v108, v60, v60, s40
    v_fma_f32 v109, v61, v61, s40
    v_fma_f32 v110, v62, v62, s40
    v_mfma_f32_32x32x16_bf16 v[64:79], a[20:23], a[68:71], v[64:79]
    s_add_u32 s72, s72, s75
    ds_read_b64_tr_b16 a[44:45], v16 offset:60416
    ds_read_b64_tr_b16 a[46:47], v16 offset:60672
    v_fma_f32 v111, v63, v63, s40
    v_mul_f32 v96, -v48, v96
    v_mul_f32 v97, -v49, v97
    v_mul_f32 v98, -v50, v98
    v_mul_f32 v99, -v51, v99
    s_waitcnt lgkmcnt(12)
    v_mfma_f32_16x16x32_bf16 v[152:155], a[0:3], a[96:99], 0
    ds_read_b64_tr_b16 a[0:1], v17 offset:49152
    ds_read_b64_tr_b16 a[2:3], v17 offset:49408
    v_mul_f32 v100, -v52, v100
    v_mul_f32 v101, -v53, v101
    v_mul_f32 v102, -v54, v102
    v_mfma_f32_16x16x32_bf16 v[152:155], a[4:7], a[100:103], v[152:155]
    ds_read_b64_tr_b16 a[4:5], v17 offset:50176
    ds_read_b64_tr_b16 a[6:7], v17 offset:50432
    v_mul_f32 v103, -v55, v103
    v_mul_f32 v104, -v56, v104
    v_mfma_f32_16x16x32_bf16 v[152:155], a[8:11], a[104:107], v[152:155]
    ds_read_b64_tr_b16 a[8:9], v17 offset:51200
    ds_read_b64_tr_b16 a[10:11], v17 offset:51456
    v_mul_f32 v105, -v57, v105
    v_mul_f32 v106, -v58, v106
    v_mul_f32 v107, -v59, v107
    v_mfma_f32_16x16x32_bf16 v[152:155], a[12:15], a[108:111], v[152:155]
    ds_read_b64_tr_b16 a[12:13], v17 offset:52224
    ds_read_b64_tr_b16 a[14:15], v17 offset:52480
    v_mul_f32 v108, -v60, v108
    v_mul_f32 v109, -v61, v109
    v_mul_f32 v110, -v62, v110
    v_mfma_f32_16x16x32_bf16 v[152:155], a[16:19], a[112:115], v[152:155]
    ds_read_b64_tr_b16 a[16:17], v17 offset:53248
    ds_read_b64_tr_b16 a[18:19], v17 offset:53504
    v_mul_f32 v111, -v63, v111
    v_exp_f32 v96, v96
    v_mfma_f32_16x16x32_bf16 v[152:155], a[20:23], a[116:119], v[152:155]
    ds_read_b64_tr_b16 a[20:21], v17 offset:54272
    ds_read_b64_tr_b16 a[22:23], v17 offset:54528
    v_exp_f32 v97, v97
    v_exp_f32 v98, v98
    v_exp_f32 v99, v99
    v_exp_f32 v100, v100
    v_exp_f32 v101, v101
    v_exp_f32 v102, v102
    v_exp_f32 v103, v103
    v_exp_f32 v104, v104
    v_exp_f32 v105, v105
    v_exp_f32 v106, v106
    v_exp_f32 v107, v107
    v_exp_f32 v108, v108
    v_exp_f32 v109, v109
    v_exp_f32 v110, v110
    v_exp_f32 v111, v111
    v_pk_fma_f32 v[156:157], v[152:153], v[152:153], s[40:41]
    v_pk_fma_f32 v[158:159], v[154:155], v[154:155], s[40:41]
    v_pk_mul_f32 v[156:157], v[152:153], v[156:157] neg_lo:[1,0] neg_hi:[1,0]
    v_pk_mul_f32 v[158:159], v[154:155], v[158:159] neg_lo:[1,0] neg_hi:[1,0]
    v_exp_f32 v156, v156
    v_exp_f32 v157, v157
    v_exp_f32 v158, v158
    v_exp_f32 v159, v159
    v_pk_fma_f32 v[96:97], v[96:97], s[42:43], s[42:43]
    v_pk_fma_f32 v[98:99], v[98:99], s[42:43], s[42:43]
    v_pk_fma_f32 v[100:101], v[100:101], s[42:43], s[42:43]
    v_pk_fma_f32 v[102:103], v[102:103], s[42:43], s[42:43]
    v_pk_fma_f32 v[104:105], v[104:105], s[42:43], s[42:43]
    v_pk_fma_f32 v[106:107], v[106:107], s[42:43], s[42:43]
    v_pk_fma_f32 v[108:109], v[108:109], s[42:43], s[42:43]
    v_pk_fma_f32 v[110:111], v[110:111], s[42:43], s[42:43]
    v_pk_fma_f32 v[112:113], v[64:65], v[64:65], s[40:41]
    v_pk_fma_f32 v[114:115], v[66:67], v[66:67], s[40:41]
    v_pk_fma_f32 v[116:117], v[68:69], v[68:69], s[40:41]
    v_pk_fma_f32 v[118:119], v[70:71], v[70:71], s[40:41]
    v_pk_fma_f32 v[120:121], v[72:73], v[72:73], s[40:41]
    v_pk_fma_f32 v[122:123], v[74:75], v[74:75], s[40:41]
    v_pk_fma_f32 v[124:125], v[76:77], v[76:77], s[40:41]
    v_pk_fma_f32 v[126:127], v[78:79], v[78:79], s[40:41]
    v_pk_mul_f32 v[112:113], v[64:65], v[112:113] neg_lo:[1,0] neg_hi:[1,0]
    v_pk_mul_f32 v[114:115], v[66:67], v[114:115] neg_lo:[1,0] neg_hi:[1,0]
    v_pk_mul_f32 v[116:117], v[68:69], v[116:117] neg_lo:[1,0] neg_hi:[1,0]
    v_pk_mul_f32 v[118:119], v[70:71], v[118:119] neg_lo:[1,0] neg_hi:[1,0]
    v_pk_mul_f32 v[120:121], v[72:73], v[120:121] neg_lo:[1,0] neg_hi:[1,0]
    v_pk_mul_f32 v[122:123], v[74:75], v[122:123] neg_lo:[1,0] neg_hi:[1,0]
    v_pk_mul_f32 v[124:125], v[76:77], v[124:125] neg_lo:[1,0] neg_hi:[1,0]
    v_pk_mul_f32 v[126:127], v[78:79], v[126:127] neg_lo:[1,0] neg_hi:[1,0]
    v_pk_fma_f32 v[156:157], v[156:157], s[42:43], s[42:43]
    v_pk_fma_f32 v[158:159], v[158:159], s[42:43], s[42:43]
    s_waitcnt lgkmcnt(0)
    v_mfma_f32_32x32x16_bf16 v[80:95], a[0:3], a[48:51], 0
    ds_read_b64_tr_b16 a[0:1], v18 offset:49152
    ds_read_b64_tr_b16 a[2:3], v18 offset:49408
    s_add_u32 m0, s63, 78848
    s_nop 0
    buffer_load_dwordx4 v23, s[68:71], s73 offen lds
    v_rcp_f32 v96, v96
    v_rcp_f32 v97, v97
    v_rcp_f32 v98, v98
    v_rcp_f32 v99, v99
    v_rcp_f32 v100, v100
    v_mfma_f32_32x32x16_bf16 v[80:95], a[4:7], a[52:55], v[80:95]
    s_add_u32 s73, s73, s75
    s_add_u32 m0, s63, 79872
    ds_read_b64_tr_b16 a[4:5], v18 offset:50176
    ds_read_b64_tr_b16 a[6:7], v18 offset:50432
    v_rcp_f32 v101, v101
    v_rcp_f32 v102, v102
    v_rcp_f32 v103, v103
    v_rcp_f32 v104, v104
    v_rcp_f32 v105, v105
    v_rcp_f32 v106, v106
    v_rcp_f32 v107, v107
    v_mfma_f32_32x32x16_bf16 v[80:95], a[8:11], a[56:59], v[80:95]
    ds_read_b64_tr_b16 a[8:9], v18 offset:51200
    ds_read_b64_tr_b16 a[10:11], v18 offset:51456
    buffer_load_dwordx4 v23, s[68:71], s74 offen lds
    v_rcp_f32 v108, v108
    v_rcp_f32 v109, v109
    v_rcp_f32 v110, v110
    v_rcp_f32 v111, v111
    v_rcp_f32 v156, v156
    v_rcp_f32 v157, v157
    v_mfma_f32_32x32x16_bf16 v[80:95], a[12:15], a[60:63], v[80:95]
    s_add_u32 s74, s74, s75
    ds_read_b64_tr_b16 a[12:13], v18 offset:52224
    ds_read_b64_tr_b16 a[14:15], v18 offset:52480
    s_add_u32 m0, s63, 65536
    s_nop 0
    buffer_load_dwordx4 v23, s[68:71], s72 offen lds
    v_rcp_f32 v158, v158
    v_rcp_f32 v159, v159
    v_exp_f32 v112, v112
    v_exp_f32 v113, v113
    v_exp_f32 v114, v114
    v_exp_f32 v115, v115
    v_mfma_f32_32x32x16_bf16 v[80:95], a[16:19], a[64:67], v[80:95]
    s_add_u32 s72, s72, s75
    s_add_u32 m0, s63, 66560
    ds_read_b64_tr_b16 a[16:17], v18 offset:53248
    ds_read_b64_tr_b16 a[18:19], v18 offset:53504
    v_exp_f32 v116, v116
    v_exp_f32 v117, v117
    v_exp_f32 v118, v118
    v_exp_f32 v119, v119
    v_exp_f32 v120, v120
    v_exp_f32 v121, v121
    v_mfma_f32_32x32x16_bf16 v[80:95], a[20:23], a[68:71], v[80:95]
    ds_read_b64_tr_b16 a[20:21], v18 offset:54272
    ds_read_b64_tr_b16 a[22:23], v18 offset:54528
    buffer_load_dwordx4 v23, s[68:71], s73 offen lds
    s_add_u32 s73, s73, s75
    v_exp_f32 v122, v122
    v_exp_f32 v123, v123
    v_exp_f32 v124, v124
    v_exp_f32 v125, v125
    v_exp_f32 v126, v126
    v_exp_f32 v127, v127
    v_pk_mul_f32 v[96:97], v[48:49], v[96:97]
    v_pk_mul_f32 v[98:99], v[50:51], v[98:99]
    v_pk_mul_f32 v[100:101], v[52:53], v[100:101]
    v_pk_mul_f32 v[102:103], v[54:55], v[102:103]
    v_pk_mul_f32 v[104:105], v[56:57], v[104:105]
    v_pk_mul_f32 v[106:107], v[58:59], v[106:107]
    v_pk_mul_f32 v[108:109], v[60:61], v[108:109]
    v_pk_mul_f32 v[110:111], v[62:63], v[110:111]
    v_pk_fma_f32 v[112:113], v[112:113], s[42:43], s[42:43]
    v_pk_fma_f32 v[114:115], v[114:115], s[42:43], s[42:43]
    v_pk_fma_f32 v[116:117], v[116:117], s[42:43], s[42:43]
    v_pk_fma_f32 v[118:119], v[118:119], s[42:43], s[42:43]
    v_pk_fma_f32 v[120:121], v[120:121], s[42:43], s[42:43]
    v_pk_fma_f32 v[122:123], v[122:123], s[42:43], s[42:43]
    v_pk_fma_f32 v[124:125], v[124:125], s[42:43], s[42:43]
    v_pk_fma_f32 v[126:127], v[126:127], s[42:43], s[42:43]
    v_pk_fma_f32 v[128:129], v[80:81], v[80:81], s[40:41]
    v_pk_fma_f32 v[130:131], v[82:83], v[82:83], s[40:41]
    v_pk_fma_f32 v[132:133], v[84:85], v[84:85], s[40:41]
    v_pk_fma_f32 v[134:135], v[86:87], v[86:87], s[40:41]
    v_pk_fma_f32 v[136:137], v[88:89], v[88:89], s[40:41]
    v_pk_fma_f32 v[138:139], v[90:91], v[90:91], s[40:41]
    v_pk_fma_f32 v[140:141], v[92:93], v[92:93], s[40:41]
    v_pk_fma_f32 v[142:143], v[94:95], v[94:95], s[40:41]
    v_pk_mul_f32 v[128:129], v[80:81], v[128:129] neg_lo:[1,0] neg_hi:[1,0]
    v_pk_mul_f32 v[130:131], v[82:83], v[130:131] neg_lo:[1,0] neg_hi:[1,0]
    v_pk_mul_f32 v[132:133], v[84:85], v[132:133] neg_lo:[1,0] neg_hi:[1,0]
    v_pk_mul_f32 v[134:135], v[86:87], v[134:135] neg_lo:[1,0] neg_hi:[1,0]
    v_pk_mul_f32 v[136:137], v[88:89], v[136:137] neg_lo:[1,0] neg_hi:[1,0]
    v_pk_mul_f32 v[138:139], v[90:91], v[138:139] neg_lo:[1,0] neg_hi:[1,0]
    v_pk_mul_f32 v[140:141], v[92:93], v[140:141] neg_lo:[1,0] neg_hi:[1,0]
    v_pk_mul_f32 v[142:143], v[94:95], v[142:143] neg_lo:[1,0] neg_hi:[1,0]
    v_pk_mul_f32 v[156:157], v[152:153], v[156:157]
    v_pk_mul_f32 v[158:159], v[154:155], v[158:159]
    s_waitcnt lgkmcnt(0)
    v_mfma_f32_32x32x16_bf16 v[48:63], a[0:3], a[72:75], 0
    v_cvt_pk_bf16_f32 v144, v96, v97
    v_rcp_f32 v112, v112
    v_cvt_pk_bf16_f32 v145, v98, v99
    v_rcp_f32 v113, v113
    v_cvt_pk_bf16_f32 v146, v100, v101
    v_mfma_f32_32x32x16_bf16 v[48:63], a[4:7], a[76:79], v[48:63]
    s_add_u32 m0, s63, 67584
    v_rcp_f32 v114, v114
    v_cvt_pk_bf16_f32 v147, v102, v103
    v_rcp_f32 v115, v115
    v_cvt_pk_bf16_f32 v148, v104, v105
    v_rcp_f32 v116, v116
    v_mfma_f32_32x32x16_bf16 v[48:63], a[8:11], a[80:83], v[48:63]
    buffer_load_dwordx4 v23, s[68:71], s74 offen lds
    v_cvt_pk_bf16_f32 v149, v106, v107
    v_rcp_f32 v117, v117
    v_cvt_pk_bf16_f32 v150, v108, v109
    v_rcp_f32 v118, v118
    v_mfma_f32_32x32x16_bf16 v[48:63], a[12:15], a[84:87], v[48:63]
    s_add_u32 s74, s74, s75
    v_cvt_pk_bf16_f32 v151, v110, v111
    v_rcp_f32 v119, v119
    v_cvt_pk_bf16_f32 v2, v156, v157
    v_rcp_f32 v120, v120
    v_mfma_f32_32x32x16_bf16 v[48:63], a[16:19], a[88:91], v[48:63]
    v_cvt_pk_bf16_f32 v3, v158, v159
    v_rcp_f32 v121, v121
    s_mov_b64 exec, s[44:45]
    s_nop 0
    ds_write_b64 v35, v[2:3]
    s_mov_b64 exec, -1
    ds_read_b128 a[120:123], v36
    ds_read_b128 a[124:127], v36 offset:128
    v_mfma_f32_32x32x16_bf16 v[48:63], a[20:23], a[92:95], v[48:63]
    s_add_u32 m0, s63, 53248
    v_rcp_f32 v122, v122
    v_rcp_f32 v123, v123
    v_mfma_f32_32x32x16_bf16 v[208:223], a[24:27], v[144:147], 0
    buffer_load_dwordx4 v23, s[68:71], s72 offen lds
    v_rcp_f32 v124, v124
    v_rcp_f32 v125, v125
    v_rcp_f32 v126, v126
    v_mfma_f32_32x32x16_bf16 v[224:239], a[28:31], v[144:147], 0
    s_add_u32 s72, s72, s75
    v_rcp_f32 v127, v127
    v_exp_f32 v128, v128
    v_exp_f32 v129, v129
    v_mfma_f32_32x32x16_bf16 v[240:255], a[32:35], v[144:147], 0
    v_exp_f32 v130, v130
    v_exp_f32 v131, v131
    v_exp_f32 v132, v132
    v_exp_f32 v133, v133
    v_mfma_f32_32x32x16_bf16 v[208:223], a[36:39], v[148:151], v[208:223]
    s_add_u32 m0, s63, 54272
    v_exp_f32 v134, v134
    v_exp_f32 v135, v135
    v_exp_f32 v136, v136
    v_exp_f32 v137, v137
    v_mfma_f32_32x32x16_bf16 v[224:239], a[40:43], v[148:151], v[224:239]
    buffer_load_dwordx4 v23, s[68:71], s73 offen lds
    v_exp_f32 v138, v138
    v_exp_f32 v139, v139
    v_mfma_f32_32x32x16_bf16 v[240:255], a[44:47], v[148:151], v[240:255]
    s_add_u32 s73, s73, s75
    v_exp_f32 v140, v140
    v_exp_f32 v141, v141
    v_exp_f32 v142, v142
    v_exp_f32 v143, v143
    v_pk_mul_f32 v[112:113], v[64:65], v[112:113]
    v_pk_mul_f32 v[114:115], v[66:67], v[114:115]
    v_pk_mul_f32 v[116:117], v[68:69], v[116:117]
    v_pk_mul_f32 v[118:119], v[70:71], v[118:119]
    v_pk_mul_f32 v[120:121], v[72:73], v[120:121]
    v_pk_mul_f32 v[122:123], v[74:75], v[122:123]
    v_pk_mul_f32 v[124:125], v[76:77], v[124:125]
    v_pk_mul_f32 v[126:127], v[78:79], v[126:127]
    v_pk_fma_f32 v[128:129], v[128:129], s[42:43], s[42:43]
    v_pk_fma_f32 v[130:131], v[130:131], s[42:43], s[42:43]
    v_pk_fma_f32 v[132:133], v[132:133], s[42:43], s[42:43]
    v_pk_fma_f32 v[134:135], v[134:135], s[42:43], s[42:43]
    v_pk_fma_f32 v[136:137], v[136:137], s[42:43], s[42:43]
    v_pk_fma_f32 v[138:139], v[138:139], s[42:43], s[42:43]
    v_pk_fma_f32 v[140:141], v[140:141], s[42:43], s[42:43]
    v_pk_fma_f32 v[142:143], v[142:143], s[42:43], s[42:43]
    v_pk_fma_f32 v[96:97], v[48:49], v[48:49], s[40:41]
    v_pk_fma_f32 v[98:99], v[50:51], v[50:51], s[40:41]
    v_pk_fma_f32 v[100:101], v[52:53], v[52:53], s[40:41]
    v_pk_fma_f32 v[102:103], v[54:55], v[54:55], s[40:41]
    v_pk_fma_f32 v[104:105], v[56:57], v[56:57], s[40:41]
    v_pk_fma_f32 v[106:107], v[58:59], v[58:59], s[40:41]
    v_pk_fma_f32 v[108:109], v[60:61], v[60:61], s[40:41]
    v_pk_fma_f32 v[110:111], v[62:63], v[62:63], s[40:41]
    v_pk_mul_f32 v[96:97], v[48:49], v[96:97] neg_lo:[1,0] neg_hi:[1,0]
    v_pk_mul_f32 v[98:99], v[50:51], v[98:99] neg_lo:[1,0] neg_hi:[1,0]
    v_pk_mul_f32 v[100:101], v[52:53], v[100:101] neg_lo:[1,0] neg_hi:[1,0]
    v_pk_mul_f32 v[102:103], v[54:55], v[102:103] neg_lo:[1,0] neg_hi:[1,0]
    v_pk_mul_f32 v[104:105], v[56:57], v[104:105] neg_lo:[1,0] neg_hi:[1,0]
    v_pk_mul_f32 v[106:107], v[58:59], v[106:107] neg_lo:[1,0] neg_hi:[1,0]
    v_pk_mul_f32 v[108:109], v[60:61], v[108:109] neg_lo:[1,0] neg_hi:[1,0]
    v_pk_mul_f32 v[110:111], v[62:63], v[110:111] neg_lo:[1,0] neg_hi:[1,0]
    s_waitcnt lgkmcnt(0)
    v_mfma_f32_32x32x16_bf16 v[64:79], a[0:3], a[48:51], 0
    ds_read_b64_tr_b16 a[0:1], v19 offset:49152
    ds_read_b64_tr_b16 a[2:3], v19 offset:49408
    v_cvt_pk_bf16_f32 v144, v112, v113
    v_rcp_f32 v128, v128
    v_cvt_pk_bf16_f32 v145, v114, v115
    v_mfma_f32_32x32x16_bf16 v[64:79], a[4:7], a[52:55], v[64:79]
    ds_read_b64_tr_b16 a[4:5], v19 offset:50176
    ds_read_b64_tr_b16 a[6:7], v19 offset:50432
    v_rcp_f32 v129, v129
    v_cvt_pk_bf16_f32 v146, v116, v117
    v_rcp_f32 v130, v130
    v_cvt_pk_bf16_f32 v147, v118, v119
    v_mfma_f32_32x32x16_bf16 v[64:79], a[8:11], a[56:59], v[64:79]
    ds_read_b64_tr_b16 a[8:9], v19 offset:51200
    ds_read_b64_tr_b16 a[10:11], v19 offset:51456
    v_rcp_f32 v131, v131
    v_cvt_pk_bf16_f32 v148, v120, v121
    v_rcp_f32 v132, v132
    v_mfma_f32_32x32x16_bf16 v[64:79], a[12:15], a[60:63], v[64:79]
    ds_read_b64_tr_b16 a[12:13], v19 offset:52224
    ds_read_b64_tr_b16 a[14:15], v19 offset:52480
    v_cvt_pk_bf16_f32 v149, v122, v123
    v_rcp_f32 v133, v133
    v_cvt_pk_bf16_f32 v150, v124, v125
    v_mfma_f32_32x32x16_bf16 v[64:79], a[16:19], a[64:67], v[64:79]
    ds_read_b64_tr_b16 a[16:17], v19 offset:53248
    ds_read_b64_tr_b16 a[18:19], v19 offset:53504
    v_rcp_f32 v134, v134
    v_cvt_pk_bf16_f32 v151, v126, v127
    v_rcp_f32 v135, v135
    v_mfma_f32_32x32x16_bf16 v[64:79], a[20:23], a[68:71], v[64:79]
    ds_read_b64_tr_b16 a[20:21], v19 offset:54272
    ds_read_b64_tr_b16 a[22:23], v19 offset:54528
    v_rcp_f32 v136, v136
    v_rcp_f32 v137, v137
    v_rcp_f32 v138, v138
    v_mfma_f32_16x16x32_bf16 a[128:131], a[24:27], a[120:123], 0
    v_rcp_f32 v139, v139
    v_mfma_f32_16x16x32_bf16 a[132:135], a[28:31], a[120:123], 0
    v_rcp_f32 v140, v140
    v_mfma_f32_16x16x32_bf16 a[136:139], a[32:35], a[120:123], 0
    s_add_u32 m0, s63, 55296
    v_rcp_f32 v141, v141
    v_rcp_f32 v142, v142
    v_mfma_f32_16x16x32_bf16 a[128:131], a[36:39], a[124:127], a[128:131]
    buffer_load_dwordx4 v23, s[68:71], s74 offen lds
    v_mfma_f32_16x16x32_bf16 a[132:135], a[40:43], a[124:127], a[132:135]
    s_add_u32 s74, s74, s75
    v_rcp_f32 v143, v143
    v_mfma_f32_16x16x32_bf16 a[136:139], a[44:47], a[124:127], a[136:139]
    v_exp_f32 v96, v96
    v_mfma_f32_32x32x16_bf16 v[160:175], a[24:27], v[144:147], 0
    ds_read_b64_tr_b16 a[24:25], v17 offset:55296
    ds_read_b64_tr_b16 a[26:27], v17 offset:55552
    v_exp_f32 v97, v97
    v_exp_f32 v98, v98
    v_exp_f32 v99, v99
    v_mfma_f32_32x32x16_bf16 v[176:191], a[28:31], v[144:147], 0
    ds_read_b64_tr_b16 a[28:29], v17 offset:56320
    ds_read_b64_tr_b16 a[30:31], v17 offset:56576
    v_exp_f32 v100, v100
    v_exp_f32 v101, v101
    v_mfma_f32_32x32x16_bf16 v[192:207], a[32:35], v[144:147], 0
    ds_read_b64_tr_b16 a[32:33], v17 offset:57344
    ds_read_b64_tr_b16 a[34:35], v17 offset:57600
    v_exp_f32 v102, v102
    v_exp_f32 v103, v103
    v_exp_f32 v104, v104
    v_mfma_f32_32x32x16_bf16 v[160:175], a[36:39], v[148:151], v[160:175]
    ds_read_b64_tr_b16 a[36:37], v17 offset:58368
    ds_read_b64_tr_b16 a[38:39], v17 offset:58624
    v_exp_f32 v105, v105
    v_exp_f32 v106, v106
    v_mfma_f32_32x32x16_bf16 v[176:191], a[40:43], v[148:151], v[176:191]
    ds_read_b64_tr_b16 a[40:41], v17 offset:59392
    ds_read_b64_tr_b16 a[42:43], v17 offset:59648
    v_exp_f32 v107, v107
    v_exp_f32 v108, v108
    v_exp_f32 v109, v109
    v_mfma_f32_32x32x16_bf16 v[192:207], a[44:47], v[148:151], v[192:207]
    ds_read_b64_tr_b16 a[44:45], v17 offset:60416
    ds_read_b64_tr_b16 a[46:47], v17 offset:60672
    v_exp_f32 v110, v110
    v_exp_f32 v111, v111
    v_pk_mul_f32 v[128:129], v[80:81], v[128:129]
    v_pk_mul_f32 v[130:131], v[82:83], v[130:131]
    v_pk_mul_f32 v[132:133], v[84:85], v[132:133]
    v_pk_mul_f32 v[134:135], v[86:87], v[134:135]
    v_pk_mul_f32 v[136:137], v[88:89], v[136:137]
    v_pk_mul_f32 v[138:139], v[90:91], v[138:139]
    v_pk_mul_f32 v[140:141], v[92:93], v[140:141]
    v_pk_mul_f32 v[142:143], v[94:95], v[142:143]
    v_pk_fma_f32 v[96:97], v[96:97], s[42:43], s[42:43]
    v_pk_fma_f32 v[98:99], v[98:99], s[42:43], s[42:43]
    v_pk_fma_f32 v[100:101], v[100:101], s[42:43], s[42:43]
    v_pk_fma_f32 v[102:103], v[102:103], s[42:43], s[42:43]
    v_pk_fma_f32 v[104:105], v[104:105], s[42:43], s[42:43]
    v_pk_fma_f32 v[106:107], v[106:107], s[42:43], s[42:43]
    v_pk_fma_f32 v[108:109], v[108:109], s[42:43], s[42:43]
    v_pk_fma_f32 v[110:111], v[110:111], s[42:43], s[42:43]
    v_pk_fma_f32 v[112:113], v[64:65], v[64:65], s[40:41]
    v_pk_fma_f32 v[114:115], v[66:67], v[66:67], s[40:41]
    v_pk_fma_f32 v[116:117], v[68:69], v[68:69], s[40:41]
    v_pk_fma_f32 v[118:119], v[70:71], v[70:71], s[40:41]
    v_pk_fma_f32 v[120:121], v[72:73], v[72:73], s[40:41]
    v_pk_fma_f32 v[122:123], v[74:75], v[74:75], s[40:41]
    v_pk_fma_f32 v[124:125], v[76:77], v[76:77], s[40:41]
    v_pk_fma_f32 v[126:127], v[78:79], v[78:79], s[40:41]
    v_pk_mul_f32 v[112:113], v[64:65], v[112:113] neg_lo:[1,0] neg_hi:[1,0]
    v_pk_mul_f32 v[114:115], v[66:67], v[114:115] neg_lo:[1,0] neg_hi:[1,0]
    v_pk_mul_f32 v[116:117], v[68:69], v[116:117] neg_lo:[1,0] neg_hi:[1,0]
    v_pk_mul_f32 v[118:119], v[70:71], v[118:119] neg_lo:[1,0] neg_hi:[1,0]
    v_pk_mul_f32 v[120:121], v[72:73], v[120:121] neg_lo:[1,0] neg_hi:[1,0]
    v_pk_mul_f32 v[122:123], v[74:75], v[122:123] neg_lo:[1,0] neg_hi:[1,0]
    v_pk_mul_f32 v[124:125], v[76:77], v[124:125] neg_lo:[1,0] neg_hi:[1,0]
    v_pk_mul_f32 v[126:127], v[78:79], v[126:127] neg_lo:[1,0] neg_hi:[1,0]
    v_cvt_pk_bf16_f32 v144, v128, v129
    v_cvt_pk_bf16_f32 v145, v130, v131
    v_cvt_pk_bf16_f32 v146, v132, v133
    v_cvt_pk_bf16_f32 v147, v134, v135
    v_cvt_pk_bf16_f32 v148, v136, v137
    v_cvt_pk_bf16_f32 v149, v138, v139
    v_cvt_pk_bf16_f32 v150, v140, v141
    v_cvt_pk_bf16_f32 v151, v142, v143
    s_waitcnt lgkmcnt(0)
    v_mfma_f32_32x32x16_bf16 v[160:175], a[24:27], v[144:147], v[160:175]
    ds_read_b64_tr_b16 a[24:25], v18 offset:55296
L_pad1:
    s_cbranch_execz L_padret
    ds_read_b64_tr_b16 a[26:27], v18 offset:55552
    v_rcp_f32 v96, v96
    v_rcp_f32 v97, v97
    v_rcp_f32 v98, v98
    v_mfma_f32_32x32x16_bf16 v[176:191], a[28:31], v[144:147], v[176:191]
    ds_read_b64_tr_b16 a[28:29], v18 offset:56320
    ds_read_b64_tr_b16 a[30:31], v18 offset:56576
    v_rcp_f32 v99, v99
    v_rcp_f32 v100, v100
    v_rcp_f32 v101, v101
    v_mfma_f32_32x32x16_bf16 v[192:207], a[32:35], v[144:147], v[192:207]
    ds_read_b64_tr_b16 a[32:33], v18 offset:57344
    ds_read_b64_tr_b16 a[34:35], v18 offset:57600
    v_rcp_f32 v102, v102
    v_rcp_f32 v103, v103
    v_rcp_f32 v104, v104
    v_mfma_f32_32x32x16_bf16 v[160:175], a[36:39], v[148:151], v[160:175]
    ds_read_b64_tr_b16 a[36:37], v18 offset:58368
    ds_read_b64_tr_b16 a[38:39], v18 offset:58624
    v_rcp_f32 v105, v105
    v_rcp_f32 v106, v106
    v_rcp_f32 v107, v107
    v_mfma_f32_32x32x16_bf16 v[176:191], a[40:43], v[148:151], v[176:191]
    ds_read_b64_tr_b16 a[40:41], v18 offset:59392
    ds_read_b64_tr_b16 a[42:43], v18 offset:59648
    v_rcp_f32 v108, v108
    v_rcp_f32 v109, v109
    v_mfma_f32_32x32x16_bf16 v[192:207], a[44:47], v[148:151], v[192:207]
    ds_read_b64_tr_b16 a[44:45], v18 offset:60416
    ds_read_b64_tr_b16 a[46:47], v18 offset:60672
    v_rcp_f32 v110, v110
    v_rcp_f32 v111, v111
    v_exp_f32 v112, v112
    s_waitcnt vmcnt(3)
    s_barrier
    v_mfma_f32_32x32x16_bf16 v[80:95], a[0:3], a[48:51], 0
    ds_read_b64_tr_b16 a[0:1], v16 offset:0
    ds_read_b64_tr_b16 a[2:3], v16 offset:256
    v_exp_f32 v113, v113
    v_exp_f32 v114, v114
    v_exp_f32 v115, v115
    v_mfma_f32_32x32x16_bf16 v[80:95], a[4:7], a[52:55], v[80:95]
    s_add_u32 m0, s63, 40960
    ds_read_b64_tr_b16 a[4:5], v16 offset:1024
    ds_read_b64_tr_b16 a[6:7], v16 offset:1280
    v_exp_f32 v116, v116
    v_exp_f32 v117, v117
    v_exp_f32 v118, v118
    v_mfma_f32_32x32x16_bf16 v[80:95], a[8:11], a[56:59], v[80:95]
    ds_read_b64_tr_b16 a[8:9], v16 offset:2048
    ds_read_b64_tr_b16 a[10:11], v16 offset:2304
    buffer_load_dwordx4 v23, s[68:71], s72 offen lds
    v_exp_f32 v119, v119
    v_exp_f32 v120, v120
    v_mfma_f32_32x32x16_bf16 v[80:95], a[12:15], a[60:63], v[80:95]
    s_add_u32 s72, s72, s75
    s_add_u32 m0, s63, 41984
    ds_read_b64_tr_b16 a[12:13], v16 offset:3072
    ds_read_b64_tr_b16 a[14:15], v16 offset:3328
    v_exp_f32 v121, v121
    v_exp_f32 v122, v122
    v_mfma_f32_32x32x16_bf16 v[80:95], a[16:19], a[64:67], v[80:95]
    ds_read_b64_tr_b16 a[16:17], v16 offset:4096
    ds_read_b64_tr_b16 a[18:19], v16 offset:4352
    buffer_load_dwordx4 v23, s[68:71], s73 offen lds
    v_exp_f32 v123, v123
    v_exp_f32 v124, v124
    v_mfma_f32_32x32x16_bf16 v[80:95], a[20:23], a[68:71], v[80:95]
    s_add_u32 s73, s73, s75
    ds_read_b64_tr_b16 a[20:21], v16 offset:5120
    ds_read_b64_tr_b16 a[22:23], v16 offset:5376
    v_exp_f32 v125, v125
    v_exp_f32 v126, v126
    v_exp_f32 v127, v127
    v_pk_mul_f32 v[96:97], v[48:49], v[96:97]
    v_pk_mul_f32 v[98:99], v[50:51], v[98:99]
    v_pk_mul_f32 v[100:101], v[52:53], v[100:101]
    v_pk_mul_f32 v[102:103], v[54:55], v[102:103]
    v_pk_mul_f32 v[104:105], v[56:57], v[104:105]
    v_pk_mul_f32 v[106:107], v[58:59], v[106:107]
    v_pk_mul_f32 v[108:109], v[60:61], v[108:109]
    v_pk_mul_f32 v[110:111], v[62:63], v[110:111]
    v_pk_fma_f32 v[112:113], v[112:113], s[42:43], s[42:43]
    v_pk_fma_f32 v[114:115], v[114:115], s[42:43], s[42:43]
    v_pk_fma_f32 v[116:117], v[116:117], s[42:43], s[42:43]
    v_pk_fma_f32 v[118:119], v[118:119], s[42:43], s[42:43]
    v_pk_fma_f32 v[120:121], v[120:121], s[42:43], s[42:43]
    v_pk_fma_f32 v[122:123], v[122:123], s[42:43], s[42:43]
    v_pk_fma_f32 v[124:125], v[124:125], s[42:43], s[42:43]
    v_pk_fma_f32 v[126:127], v[126:127], s[42:43], s[42:43]
    v_pk_fma_f32 v[128:129], v[80:81], v[80:81], s[40:41]
    v_pk_fma_f32 v[130:131], v[82:83], v[82:83], s[40:41]
    v_pk_fma_f32 v[132:133], v[84:85], v[84:85], s[40:41]
    v_pk_fma_f32 v[134:135], v[86:87], v[86:87], s[40:41]
    v_pk_fma_f32 v[136:137], v[88:89], v[88:89], s[40:41]
    v_pk_fma_f32 v[138:139], v[90:91], v[90:91], s[40:41]
    v_pk_fma_f32 v[140:141], v[92:93], v[92:93], s[40:41]
    v_pk_fma_f32 v[142:143], v[94:95], v[94:95], s[40:41]
    v_pk_mul_f32 v[128:129], v[80:81], v[128:129] neg_lo:[1,0] neg_hi:[1,0]
    v_pk_mul_f32 v[130:131], v[82:83], v[130:131] neg_lo:[1,0] neg_hi:[1,0]
    v_pk_mul_f32 v[132:133], v[84:85], v[132:133] neg_lo:[1,0] neg_hi:[1,0]
    v_pk_mul_f32 v[134:135], v[86:87], v[134:135] neg_lo:[1,0] neg_hi:[1,0]
    v_pk_mul_f32 v[136:137], v[88:89], v[136:137] neg_lo:[1,0] neg_hi:[1,0]
    v_pk_mul_f32 v[138:139], v[90:91], v[138:139] neg_lo:[1,0] neg_hi:[1,0]
    v_pk_mul_f32 v[140:141], v[92:93], v[140:141] neg_lo:[1,0] neg_hi:[1,0]
    v_pk_mul_f32 v[142:143], v[94:95], v[142:143] neg_lo:[1,0] neg_hi:[1,0]
    s_waitcnt lgkmcnt(0)
    v_mfma_f32_16x16x32_bf16 v[152:155], a[0:3], a[96:99], 0
    v_cvt_pk_bf16_f32 v144, v96, v97
    v_rcp_f32 v112, v112
    v_mfma_f32_16x16x32_bf16 v[152:155], a[4:7], a[100:103], v[152:155]
    s_add_u32 m0, s63, 43008
    v_cvt_pk_bf16_f32 v145, v98, v99
    v_mfma_f32_16x16x32_bf16 v[152:155], a[8:11], a[104:107], v[152:155]
    buffer_load_dwordx4 v23, s[68:71], s74 offen lds
    v_mfma_f32_16x16x32_bf16 v[152:155], a[12:15], a[108:111], v[152:155]
    s_add_u32 s74, s74, s75
    v_rcp_f32 v113, v113
    v_mfma_f32_16x16x32_bf16 v[152:155], a[16:19], a[112:115], v[152:155]
    v_cvt_pk_bf16_f32 v146, v100, v101
    v_rcp_f32 v114, v114
    v_mfma_f32_16x16x32_bf16 v[152:155], a[20:23], a[116:119], v[152:155]
    s_add_u32 m0, s63, 28672
    v_cvt_pk_bf16_f32 v147, v102, v103
    v_mfma_f32_32x32x16_bf16 v[48:63], a[0:3], a[72:75], 0
    buffer_load_dwordx4 v23, s[68:71], s72 offen lds
    v_rcp_f32 v115, v115
    v_cvt_pk_bf16_f32 v148, v104, v105
    v_rcp_f32 v116, v116
    v_mfma_f32_32x32x16_bf16 v[48:63], a[4:7], a[76:79], v[48:63]
    s_add_u32 s72, s72, s75
    v_cvt_pk_bf16_f32 v149, v106, v107
    v_rcp_f32 v117, v117
    v_cvt_pk_bf16_f32 v150, v108, v109
    v_rcp_f32 v118, v118
    v_mfma_f32_32x32x16_bf16 v[48:63], a[8:11], a[80:83], v[48:63]
    v_cvt_pk_bf16_f32 v151, v110, v111
    v_rcp_f32 v119, v119
    v_rcp_f32 v120, v120
    v_mfma_f32_32x32x16_bf16 v[48:63], a[12:15], a[84:87], v[48:63]
    v_rcp_f32 v121, v121
    v_rcp_f32 v122, v122
    v_rcp_f32 v123, v123
    v_mfma_f32_32x32x16_bf16 v[48:63], a[16:19], a[88:91], v[48:63]
    s_add_u32 m0, s63, 29696
    v_rcp_f32 v124, v124
    v_rcp_f32 v125, v125
    v_rcp_f32 v126, v126
    v_mfma_f32_32x32x16_bf16 v[48:63], a[20:23], a[92:95], v[48:63]
    buffer_load_dwordx4 v23, s[68:71], s73 offen lds
    v_rcp_f32 v127, v127
    v_exp_f32 v128, v128
    v_mfma_f32_32x32x16_bf16 v[208:223], a[24:27], v[144:147], v[208:223]
    s_add_u32 s73, s73, s75
    v_exp_f32 v129, v129
    v_exp_f32 v130, v130
    v_exp_f32 v131, v131
    v_mfma_f32_32x32x16_bf16 v[224:239], a[28:31], v[144:147], v[224:239]
    v_exp_f32 v132, v132
    v_exp_f32 v133, v133
    v_exp_f32 v134, v134
    v_mfma_f32_32x32x16_bf16 v[240:255], a[32:35], v[144:147], v[240:255]
    s_add_u32 m0, s63, 30720
    v_exp_f32 v135, v135
    v_exp_f32 v136, v136
    v_exp_f32 v137, v137
    v_mfma_f32_32x32x16_bf16 v[208:223], a[36:39], v[148:151], v[208:223]
    buffer_load_dwordx4 v23, s[68:71], s74 offen lds
    v_exp_f32 v138, v138
    v_exp_f32 v139, v139
    v_mfma_f32_32x32x16_bf16 v[224:239], a[40:43], v[148:151], v[224:239]
    s_add_u32 s74, s74, s75
    v_exp_f32 v140, v140
    v_exp_f32 v141, v141
    v_exp_f32 v142, v142
    v_mfma_f32_32x32x16_bf16 v[240:255], a[44:47], v[148:151], v[240:255]
    v_exp_f32 v143, v143
    v_pk_mul_f32 v[112:113], v[64:65], v[112:113]
    v_pk_mul_f32 v[114:115], v[66:67], v[114:115]
    v_pk_mul_f32 v[116:117], v[68:69], v[116:117]
    v_pk_mul_f32 v[118:119], v[70:71], v[118:119]
    v_pk_mul_f32 v[120:121], v[72:73], v[120:121]
    v_pk_mul_f32 v[122:123], v[74:75], v[122:123]
    v_pk_mul_f32 v[124:125], v[76:77], v[124:125]
    v_pk_mul_f32 v[126:127], v[78:79], v[126:127]
    v_pk_fma_f32 v[128:129], v[128:129], s[42:43], s[42:43]
    v_pk_fma_f32 v[130:131], v[130:131], s[42:43], s[42:43]
    v_pk_fma_f32 v[132:133], v[132:133], s[42:43], s[42:43]
    v_pk_fma_f32 v[134:135], v[134:135], s[42:43], s[42:43]
    v_pk_fma_f32 v[136:137], v[136:137], s[42:43], s[42:43]
    v_pk_fma_f32 v[138:139], v[138:139], s[42:43], s[42:43]
    v_pk_fma_f32 v[140:141], v[140:141], s[42:43], s[42:43]
    v_pk_fma_f32 v[142:143], v[142:143], s[42:43], s[42:43]
    v_pk_fma_f32 v[96:97], v[48:49], v[48:49], s[40:41]
    v_pk_fma_f32 v[98:99], v[50:51], v[50:51], s[40:41]
    v_pk_fma_f32 v[100:101], v[52:53], v[52:53], s[40:41]
    v_pk_fma_f32 v[102:103], v[54:55], v[54:55], s[40:41]
    v_pk_fma_f32 v[104:105], v[56:57], v[56:57], s[40:41]
    v_pk_fma_f32 v[106:107], v[58:59], v[58:59], s[40:41]
    v_pk_fma_f32 v[108:109], v[60:61], v[60:61], s[40:41]
    v_pk_fma_f32 v[110:111], v[62:63], v[62:63], s[40:41]
    v_pk_mul_f32 v[96:97], v[48:49], v[96:97] neg_lo:[1,0] neg_hi:[1,0]
    v_pk_mul_f32 v[98:99], v[50:51], v[98:99] neg_lo:[1,0] neg_hi:[1,0]
    v_pk_mul_f32 v[100:101], v[52:53], v[100:101] neg_lo:[1,0] neg_hi:[1,0]
    v_pk_mul_f32 v[102:103], v[54:55], v[102:103] neg_lo:[1,0] neg_hi:[1,0]
    v_pk_mul_f32 v[104:105], v[56:57], v[104:105] neg_lo:[1,0] neg_hi:[1,0]
    v_pk_mul_f32 v[106:107], v[58:59], v[106:107] neg_lo:[1,0] neg_hi:[1,0]
    v_pk_mul_f32 v[108:109], v[60:61], v[108:109] neg_lo:[1,0] neg_hi:[1,0]
    v_pk_mul_f32 v[110:111], v[62:63], v[110:111] neg_lo:[1,0] neg_hi:[1,0]
    v_pk_fma_f32 v[156:157], v[152:153], v[152:153], s[40:41]
    v_pk_fma_f32 v[158:159], v[154:155], v[154:155], s[40:41]
    v_pk_mul_f32 v[156:157], v[152:153], v[156:157] neg_lo:[1,0] neg_hi:[1,0]
    v_pk_mul_f32 v[158:159], v[154:155], v[158:159] neg_lo:[1,0] neg_hi:[1,0]
    s_waitcnt lgkmcnt(0)
    v_mfma_f32_32x32x16_bf16 v[64:79], a[0:3], a[48:51], 0
    ds_read_b64_tr_b16 a[0:1], v17 offset:0
    ds_read_b64_tr_b16 a[2:3], v17 offset:256
    v_cvt_pk_bf16_f32 v144, v112, v113
    v_rcp_f32 v128, v128
    v_cvt_pk_bf16_f32 v145, v114, v115
    v_rcp_f32 v129, v129
    v_cvt_pk_bf16_f32 v146, v116, v117
    v_mfma_f32_32x32x16_bf16 v[64:79], a[4:7], a[52:55], v[64:79]
    s_add_u32 m0, s63, 16384
    ds_read_b64_tr_b16 a[4:5], v17 offset:1024
    ds_read_b64_tr_b16 a[6:7], v17 offset:1280
    v_rcp_f32 v130, v130
    v_cvt_pk_bf16_f32 v147, v118, v119
    v_rcp_f32 v131, v131
    v_cvt_pk_bf16_f32 v148, v120, v121
    v_rcp_f32 v132, v132
    v_mfma_f32_32x32x16_bf16 v[64:79], a[8:11], a[56:59], v[64:79]
    ds_read_b64_tr_b16 a[8:9], v17 offset:2048
    ds_read_b64_tr_b16 a[10:11], v17 offset:2304
    buffer_load_dwordx4 v23, s[68:71], s72 offen lds
    v_cvt_pk_bf16_f32 v149, v122, v123
    v_rcp_f32 v133, v133
    v_cvt_pk_bf16_f32 v150, v124, v125
    v_mfma_f32_32x32x16_bf16 v[64:79], a[12:15], a[60:63], v[64:79]
    s_add_u32 s72, s72, s75
    ds_read_b64_tr_b16 a[12:13], v17 offset:3072
    ds_read_b64_tr_b16 a[14:15], v17 offset:3328
    v_rcp_f32 v134, v134
    v_cvt_pk_bf16_f32 v151, v126, v127
    v_rcp_f32 v135, v135
    v_rcp_f32 v136, v136
    v_mfma_f32_32x32x16_bf16 v[64:79], a[16:19], a[64:67], v[64:79]
    ds_read_b64_tr_b16 a[16:17], v17 offset:4096
    ds_read_b64_tr_b16 a[18:19], v17 offset:4352
    v_rcp_f32 v137, v137
    v_rcp_f32 v138, v138
    v_rcp_f32 v139, v139
    v_rcp_f32 v140, v140
    v_mfma_f32_32x32x16_bf16 v[64:79], a[20:23], a[68:71], v[64:79]
    s_add_u32 m0, s63, 17408
    ds_read_b64_tr_b16 a[20:21], v17 offset:5120
    ds_read_b64_tr_b16 a[22:23], v17 offset:5376
    v_rcp_f32 v141, v141
    v_rcp_f32 v142, v142
    v_rcp_f32 v143, v143
    v_mfma_f32_32x32x16_bf16 v[160:175], a[24:27], v[144:147], v[160:175]
    ds_read_b64_tr_b16 a[24:25], v19 offset:55296
    ds_read_b64_tr_b16 a[26:27], v19 offset:55552
    buffer_load_dwordx4 v23, s[68:71], s73 offen lds
    v_exp_f32 v96, v96
    v_exp_f32 v97, v97
    v_exp_f32 v98, v98
    v_mfma_f32_32x32x16_bf16 v[176:191], a[28:31], v[144:147], v[176:191]
    s_add_u32 s73, s73, s75
    ds_read_b64_tr_b16 a[28:29], v19 offset:56320
    ds_read_b64_tr_b16 a[30:31], v19 offset:56576
    v_exp_f32 v99, v99
    v_exp_f32 v100, v100
    v_exp_f32 v101, v101
    v_exp_f32 v102, v102
    v_mfma_f32_32x32x16_bf16 v[192:207], a[32:35], v[144:147], v[192:207]
    ds_read_b64_tr_b16 a[32:33], v19 offset:57344
    ds_read_b64_tr_b16 a[34:35], v19 offset:57600
    v_exp_f32 v103, v103
    v_exp_f32 v104, v104
    v_exp_f32 v105, v105
    v_mfma_f32_32x32x16_bf16 v[160:175], a[36:39], v[148:151], v[160:175]
    s_add_u32 m0, s63, 18432
    ds_read_b64_tr_b16 a[36:37], v19 offset:58368
    ds_read_b64_tr_b16 a[38:39], v19 offset:58624
    v_exp_f32 v106, v106
    v_exp_f32 v107, v107
    v_exp_f32 v108, v108
    v_exp_f32 v109, v109
    v_mfma_f32_32x32x16_bf16 v[176:191], a[40:43], v[148:151], v[176:191]
    ds_read_b64_tr_b16 a[40:41], v19 offset:59392
    ds_read_b64_tr_b16 a[42:43], v19 offset:59648
    buffer_load_dwordx4 v23, s[68:71], s74 offen lds
    v_exp_f32 v110, v110
    v_exp_f32 v111, v111
    v_mfma_f32_32x32x16_bf16 v[192:207], a[44:47], v[148:151], v[192:207]
    s_add_u32 s74, s74, s75
    ds_read_b64_tr_b16 a[44:45], v19 offset:60416
    ds_read_b64_tr_b16 a[46:47], v19 offset:60672
    v_exp_f32 v156, v156
    v_exp_f32 v157, v157
    v_exp_f32 v158, v158
    v_exp_f32 v159, v159
    v_pk_mul_f32 v[128:129], v[80:81], v[128:129]
    v_pk_mul_f32 v[130:131], v[82:83], v[130:131]
    v_pk_mul_f32 v[132:133], v[84:85], v[132:133]
    v_pk_mul_f32 v[134:135], v[86:87], v[134:135]
    v_pk_mul_f32 v[136:137], v[88:89], v[136:137]
    v_pk_mul_f32 v[138:139], v[90:91], v[138:139]
    v_pk_mul_f32 v[140:141], v[92:93], v[140:141]
    v_pk_mul_f32 v[142:143], v[94:95], v[142:143]
    v_pk_fma_f32 v[96:97], v[96:97], s[42:43], s[42:43]
    v_pk_fma_f32 v[98:99], v[98:99], s[42:43], s[42:43]
    v_pk_fma_f32 v[100:101], v[100:101], s[42:43], s[42:43]
    v_pk_fma_f32 v[102:103], v[102:103], s[42:43], s[42:43]
    v_pk_fma_f32 v[104:105], v[104:105], s[42:43], s[42:43]
    v_pk_fma_f32 v[106:107], v[106:107], s[42:43], s[42:43]
    v_pk_fma_f32 v[108:109], v[108:109], s[42:43], s[42:43]
    v_pk_fma_f32 v[110:111], v[110:111], s[42:43], s[42:43]
    v_pk_fma_f32 v[112:113], v[64:65], v[64:65], s[40:41]
    v_pk_fma_f32 v[114:115], v[66:67], v[66:67], s[40:41]
    v_pk_fma_f32 v[116:117], v[68:69], v[68:69], s[40:41]
    v_pk_fma_f32 v[118:119], v[70:71], v[70:71], s[40:41]
    v_pk_fma_f32 v[120:121], v[72:73], v[72:73], s[40:41]
    v_pk_fma_f32 v[122:123], v[74:75], v[74:75], s[40:41]
    v_pk_fma_f32 v[124:125], v[76:77], v[76:77], s[40:41]
    v_pk_fma_f32 v[126:127], v[78:79], v[78:79], s[40:41]
    v_pk_mul_f32 v[112:113], v[64:65], v[112:113] neg_lo:[1,0] neg_hi:[1,0]
    v_pk_mul_f32 v[114:115], v[66:67], v[114:115] neg_lo:[1,0] neg_hi:[1,0]
    v_pk_mul_f32 v[116:117], v[68:69], v[116:117] neg_lo:[1,0] neg_hi:[1,0]
    v_pk_mul_f32 v[118:119], v[70:71], v[118:119] neg_lo:[1,0] neg_hi:[1,0]
    v_pk_mul_f32 v[120:121], v[72:73], v[120:121] neg_lo:[1,0] neg_hi:[1,0]
    v_pk_mul_f32 v[122:123], v[74:75], v[122:123] neg_lo:[1,0] neg_hi:[1,0]
    v_pk_mul_f32 v[124:125], v[76:77], v[124:125] neg_lo:[1,0] neg_hi:[1,0]
    v_pk_mul_f32 v[126:127], v[78:79], v[126:127] neg_lo:[1,0] neg_hi:[1,0]
    v_pk_fma_f32 v[156:157], v[156:157], s[42:43], s[42:43]
    v_pk_fma_f32 v[158:159], v[158:159], s[42:43], s[42:43]
    s_waitcnt lgkmcnt(0)
    v_mfma_f32_32x32x16_bf16 v[80:95], a[0:3], a[48:51], 0
    ds_read_b64_tr_b16 a[0:1], v18 offset:0
    ds_read_b64_tr_b16 a[2:3], v18 offset:256
    v_cvt_pk_bf16_f32 v144, v128, v129
    v_rcp_f32 v96, v96
    v_cvt_pk_bf16_f32 v145, v130, v131
    v_rcp_f32 v97, v97
    v_cvt_pk_bf16_f32 v146, v132, v133
    v_mfma_f32_32x32x16_bf16 v[80:95], a[4:7], a[52:55], v[80:95]
    ds_read_b64_tr_b16 a[4:5], v18 offset:1024
    ds_read_b64_tr_b16 a[6:7], v18 offset:1280
    buffer_load_dwordx4 v[4:7], v22, s[64:67], s59 offen offset:0
    v_rcp_f32 v98, v98
    v_cvt_pk_bf16_f32 v147, v134, v135
    v_rcp_f32 v99, v99
    v_cvt_pk_bf16_f32 v148, v136, v137
    v_mfma_f32_32x32x16_bf16 v[80:95], a[8:11], a[56:59], v[80:95]
    ds_read_b64_tr_b16 a[8:9], v18 offset:2048
    ds_read_b64_tr_b16 a[10:11], v18 offset:2304
    v_rcp_f32 v100, v100
    v_cvt_pk_bf16_f32 v149, v138, v139
    v_rcp_f32 v101, v101
    v_cvt_pk_bf16_f32 v150, v140, v141
    v_rcp_f32 v102, v102
    v_mfma_f32_32x32x16_bf16 v[80:95], a[12:15], a[60:63], v[80:95]
    ds_read_b64_tr_b16 a[12:13], v18 offset:3072
    ds_read_b64_tr_b16 a[14:15], v18 offset:3328
    v_cvt_pk_bf16_f32 v151, v142, v143
    v_rcp_f32 v103, v103
    v_rcp_f32 v104, v104
    v_rcp_f32 v105, v105
    v_mfma_f32_32x32x16_bf16 v[80:95], a[16:19], a[64:67], v[80:95]
    ds_read_b64_tr_b16 a[16:17], v18 offset:4096
    ds_read_b64_tr_b16 a[18:19], v18 offset:4352
    buffer_load_dwordx4 v[8:11], v22, s[64:67], s59 offen offset:1024
    v_rcp_f32 v106, v106
    v_rcp_f32 v107, v107
    v_mfma_f32_32x32x16_bf16 v[80:95], a[20:23], a[68:71], v[80:95]
    ds_read_b64_tr_b16 a[20:21], v18 offset:5120
    ds_read_b64_tr_b16 a[22:23], v18 offset:5376
    v_rcp_f32 v108, v108
    v_rcp_f32 v109, v109
    v_rcp_f32 v110, v110
    v_rcp_f32 v111, v111
    v_mfma_f32_32x32x16_bf16 v[160:175], a[24:27], v[144:147], v[160:175]
    ds_read_b64_tr_b16 a[24:25], v16 offset:6144
    ds_read_b64_tr_b16 a[26:27], v16 offset:6400
    v_rcp_f32 v156, v156
    v_rcp_f32 v157, v157
    v_rcp_f32 v158, v158
    v_rcp_f32 v159, v159
    v_mfma_f32_32x32x16_bf16 v[176:191], a[28:31], v[144:147], v[176:191]
    ds_read_b64_tr_b16 a[28:29], v16 offset:7168
    ds_read_b64_tr_b16 a[30:31], v16 offset:7424
    buffer_load_dwordx4 a[140:143], v28, s[4:7], s3 offen offset:0
    v_exp_f32 v112, v112
    v_exp_f32 v113, v113
    v_mfma_f32_32x32x16_bf16 v[192:207], a[32:35], v[144:147], v[192:207]
    ds_read_b64_tr_b16 a[32:33], v16 offset:8192
    ds_read_b64_tr_b16 a[34:35], v16 offset:8448
    v_exp_f32 v114, v114
    v_exp_f32 v115, v115
    v_exp_f32 v116, v116
    v_exp_f32 v117, v117
    v_mfma_f32_32x32x16_bf16 v[160:175], a[36:39], v[148:151], v[160:175]
    ds_read_b64_tr_b16 a[36:37], v16 offset:9216
    ds_read_b64_tr_b16 a[38:39], v16 offset:9472
    v_exp_f32 v118, v118
    v_exp_f32 v119, v119
    v_exp_f32 v120, v120
    v_exp_f32 v121, v121
    v_mfma_f32_32x32x16_bf16 v[176:191], a[40:43], v[148:151], v[176:191]
    ds_read_b64_tr_b16 a[40:41], v16 offset:10240
    ds_read_b64_tr_b16 a[42:43], v16 offset:10496
    buffer_load_dwordx4 a[144:147], v28, s[4:7], s58 offen offset:0
    v_exp_f32 v122, v122
    v_exp_f32 v123, v123
    v_mfma_f32_32x32x16_bf16 v[192:207], a[44:47], v[148:151], v[192:207]
    ds_read_b64_tr_b16 a[44:45], v16 offset:11264
    ds_read_b64_tr_b16 a[46:47], v16 offset:11520
    v_exp_f32 v124, v124
    v_exp_f32 v125, v125
    v_exp_f32 v126, v126
    v_exp_f32 v127, v127
    v_pk_mul_f32 v[96:97], v[48:49], v[96:97]
    v_pk_mul_f32 v[98:99], v[50:51], v[98:99]
    v_pk_mul_f32 v[100:101], v[52:53], v[100:101]
    v_pk_mul_f32 v[102:103], v[54:55], v[102:103]
    v_pk_mul_f32 v[104:105], v[56:57], v[104:105]
    v_pk_mul_f32 v[106:107], v[58:59], v[106:107]
    v_pk_mul_f32 v[108:109], v[60:61], v[108:109]
    v_pk_mul_f32 v[110:111], v[62:63], v[110:111]
    v_pk_fma_f32 v[112:113], v[112:113], s[42:43], s[42:43]
    v_pk_fma_f32 v[114:115], v[114:115], s[42:43], s[42:43]
    v_pk_fma_f32 v[116:117], v[116:117], s[42:43], s[42:43]
    v_pk_fma_f32 v[118:119], v[118:119], s[42:43], s[42:43]
    v_pk_fma_f32 v[120:121], v[120:121], s[42:43], s[42:43]
    v_pk_fma_f32 v[122:123], v[122:123], s[42:43], s[42:43]
    v_pk_fma_f32 v[124:125], v[124:125], s[42:43], s[42:43]
    v_pk_fma_f32 v[126:127], v[126:127], s[42:43], s[42:43]
    v_pk_fma_f32 v[128:129], v[80:81], v[80:81], s[40:41]
    v_pk_fma_f32 v[130:131], v[82:83], v[82:83], s[40:41]
    v_pk_fma_f32 v[132:133], v[84:85], v[84:85], s[40:41]
    v_pk_fma_f32 v[134:135], v[86:87], v[86:87], s[40:41]
    v_pk_fma_f32 v[136:137], v[88:89], v[88:89], s[40:41]
    v_pk_fma_f32 v[138:139], v[90:91], v[90:91], s[40:41]
    v_pk_fma_f32 v[140:141], v[92:93], v[92:93], s[40:41]
    v_pk_fma_f32 v[142:143], v[94:95], v[94:95], s[40:41]
    v_pk_mul_f32 v[128:129], v[80:81], v[128:129] neg_lo:[1,0] neg_hi:[1,0]
    v_pk_mul_f32 v[130:131], v[82:83], v[130:131] neg_lo:[1,0] neg_hi:[1,0]
    v_pk_mul_f32 v[132:133], v[84:85], v[132:133] neg_lo:[1,0] neg_hi:[1,0]
    v_pk_mul_f32 v[134:135], v[86:87], v[134:135] neg_lo:[1,0] neg_hi:[1,0]
    v_pk_mul_f32 v[136:137], v[88:89], v[136:137] neg_lo:[1,0] neg_hi:[1,0]
    v_pk_mul_f32 v[138:139], v[90:91], v[138:139] neg_lo:[1,0] neg_hi:[1,0]
    v_pk_mul_f32 v[140:141], v[92:93], v[140:141] neg_lo:[1,0] neg_hi:[1,0]
    v_pk_mul_f32 v[142:143], v[94:95], v[142:143] neg_lo:[1,0] neg_hi:[1,0]
    v_pk_mul_f32 v[156:157], v[152:153], v[156:157]
    v_pk_mul_f32 v[158:159], v[154:155], v[158:159]
    s_waitcnt lgkmcnt(0)
    v_mfma_f32_32x32x16_bf16 v[48:63], a[0:3], a[48:51], 0
    ds_read_b64_tr_b16 a[0:1], v19 offset:0
    ds_read_b64_tr_b16 a[2:3], v19 offset:256
    v_cvt_pk_bf16_f32 v144, v96, v97
    v_rcp_f32 v112, v112
    v_cvt_pk_bf16_f32 v145, v98, v99
    v_rcp_f32 v113, v113
    v_cvt_pk_bf16_f32 v146, v100, v101
    v_mfma_f32_32x32x16_bf16 v[48:63], a[4:7], a[52:55], v[48:63]
    ds_read_b64_tr_b16 a[4:5], v19 offset:1024
    ds_read_b64_tr_b16 a[6:7], v19 offset:1280
    v_rcp_f32 v114, v114
    v_cvt_pk_bf16_f32 v147, v102, v103
    v_rcp_f32 v115, v115
    v_cvt_pk_bf16_f32 v148, v104, v105
    v_mfma_f32_32x32x16_bf16 v[48:63], a[8:11], a[56:59], v[48:63]
    ds_read_b64_tr_b16 a[8:9], v19 offset:2048
    ds_read_b64_tr_b16 a[10:11], v19 offset:2304
    v_rcp_f32 v116, v116
    v_cvt_pk_bf16_f32 v149, v106, v107
    v_rcp_f32 v117, v117
    v_cvt_pk_bf16_f32 v150, v108, v109
    v_mfma_f32_32x32x16_bf16 v[48:63], a[12:15], a[60:63], v[48:63]
    ds_read_b64_tr_b16 a[12:13], v19 offset:3072
    ds_read_b64_tr_b16 a[14:15], v19 offset:3328
    v_rcp_f32 v118, v118
    v_cvt_pk_bf16_f32 v151, v110, v111
    v_rcp_f32 v119, v119
    v_cvt_pk_bf16_f32 v2, v156, v157
    v_rcp_f32 v120, v120
    v_mfma_f32_32x32x16_bf16 v[48:63], a[16:19], a[64:67], v[48:63]
    ds_read_b64_tr_b16 a[16:17], v19 offset:4096
    ds_read_b64_tr_b16 a[18:19], v19 offset:4352
    v_cvt_pk_bf16_f32 v3, v158, v159
    v_rcp_f32 v121, v121
    v_mfma_f32_32x32x16_bf16 v[48:63], a[20:23], a[68:71], v[48:63]
    ds_read_b64_tr_b16 a[20:21], v19 offset:5120
    ds_read_b64_tr_b16 a[22:23], v19 offset:5376
    s_mov_b64 exec, s[44:45]
    s_nop 0
    ds_write_b64 v35, v[2:3]
    s_mov_b64 exec, -1
    ds_read_b128 a[120:123], v36
    ds_read_b128 a[124:127], v36 offset:128
    v_rcp_f32 v122, v122
    v_mfma_f32_32x32x16_bf16 v[208:223], a[24:27], v[144:147], v[208:223]
    buffer_load_dwordx4 a[148:151], v28, s[4:7], s3 offen offset:64
    v_rcp_f32 v123, v123
    v_rcp_f32 v124, v124
    v_rcp_f32 v125, v125
    v_mfma_f32_32x32x16_bf16 v[224:239], a[28:31], v[144:147], v[224:239]
    v_rcp_f32 v126, v126
    v_rcp_f32 v127, v127
    v_exp_f32 v128, v128
    v_exp_f32 v129, v129
    v_mfma_f32_32x32x16_bf16 v[240:255], a[32:35], v[144:147], v[240:255]
    buffer_load_dwordx4 a[152:155], v28, s[4:7], s58 offen offset:64
    v_exp_f32 v130, v130
    v_exp_f32 v131, v131
    v_exp_f32 v132, v132
    v_mfma_f32_32x32x16_bf16 v[208:223], a[36:39], v[148:151], v[208:223]
    buffer_load_dwordx4 a[156:159], v28, s[4:7], s3 offen offset:128
    v_exp_f32 v133, v133
    v_exp_f32 v134, v134
    v_exp_f32 v135, v135
    v_exp_f32 v136, v136
    v_mfma_f32_32x32x16_bf16 v[224:239], a[40:43], v[148:151], v[224:239]
    v_exp_f32 v137, v137
    v_exp_f32 v138, v138
    v_exp_f32 v139, v139
    v_exp_f32 v140, v140
    v_mfma_f32_32x32x16_bf16 v[240:255], a[44:47], v[148:151], v[240:255]
    buffer_load_dwordx4 a[160:163], v28, s[4:7], s58 offen offset:128
    v_exp_f32 v141, v141
    v_exp_f32 v142, v142
    v_exp_f32 v143, v143
    v_pk_mul_f32 v[112:113], v[64:65], v[112:113]
    v_pk_mul_f32 v[114:115], v[66:67], v[114:115]
    v_pk_mul_f32 v[116:117], v[68:69], v[116:117]
    v_pk_mul_f32 v[118:119], v[70:71], v[118:119]
    v_pk_mul_f32 v[120:121], v[72:73], v[120:121]
    v_pk_mul_f32 v[122:123], v[74:75], v[122:123]
    v_pk_mul_f32 v[124:125], v[76:77], v[124:125]
    v_pk_mul_f32 v[126:127], v[78:79], v[126:127]
    v_pk_fma_f32 v[128:129], v[128:129], s[42:43], s[42:43]
    v_pk_fma_f32 v[130:131], v[130:131], s[42:43], s[42:43]
    v_pk_fma_f32 v[132:133], v[132:133], s[42:43], s[42:43]
    v_pk_fma_f32 v[134:135], v[134:135], s[42:43], s[42:43]
    v_pk_fma_f32 v[136:137], v[136:137], s[42:43], s[42:43]
    v_pk_fma_f32 v[138:139], v[138:139], s[42:43], s[42:43]
    v_pk_fma_f32 v[140:141], v[140:141], s[42:43], s[42:43]
    v_pk_fma_f32 v[142:143], v[142:143], s[42:43], s[42:43]
    v_pk_fma_f32 v[96:97], v[48:49], v[48:49], s[40:41]
    v_pk_fma_f32 v[98:99], v[50:51], v[50:51], s[40:41]
    v_pk_fma_f32 v[100:101], v[52:53], v[52:53], s[40:41]
    v_pk_fma_f32 v[102:103], v[54:55], v[54:55], s[40:41]
    v_pk_fma_f32 v[104:105], v[56:57], v[56:57], s[40:41]
    v_pk_fma_f32 v[106:107], v[58:59], v[58:59], s[40:41]
    v_pk_fma_f32 v[108:109], v[60:61], v[60:61], s[40:41]
    v_pk_fma_f32 v[110:111], v[62:63], v[62:63], s[40:41]
    v_pk_mul_f32 v[96:97], v[48:49], v[96:97] neg_lo:[1,0] neg_hi:[1,0]
    v_pk_mul_f32 v[98:99], v[50:51], v[98:99] neg_lo:[1,0] neg_hi:[1,0]
    v_pk_mul_f32 v[100:101], v[52:53], v[100:101] neg_lo:[1,0] neg_hi:[1,0]
    v_pk_mul_f32 v[102:103], v[54:55], v[102:103] neg_lo:[1,0] neg_hi:[1,0]
    v_pk_mul_f32 v[104:105], v[56:57], v[104:105] neg_lo:[1,0] neg_hi:[1,0]
    v_pk_mul_f32 v[106:107], v[58:59], v[106:107] neg_lo:[1,0] neg_hi:[1,0]
    v_pk_mul_f32 v[108:109], v[60:61], v[108:109] neg_lo:[1,0] neg_hi:[1,0]
    v_pk_mul_f32 v[110:111], v[62:63], v[110:111] neg_lo:[1,0] neg_hi:[1,0]
    v_cvt_pk_bf16_f32 v144, v112, v113
    v_cvt_pk_bf16_f32 v145, v114, v115
    v_cvt_pk_bf16_f32 v146, v116, v117
    v_cvt_pk_bf16_f32 v147, v118, v119
    v_cvt_pk_bf16_f32 v148, v120, v121
    v_cvt_pk_bf16_f32 v149, v122, v123
    v_cvt_pk_bf16_f32 v150, v124, v125
    v_cvt_pk_bf16_f32 v151, v126, v127
    s_waitcnt lgkmcnt(0)
    v_mfma_f32_16x16x32_bf16 a[128:131], a[24:27], a[120:123], a[128:131]
    v_rcp_f32 v128, v128
    v_mfma_f32_16x16x32_bf16 a[132:135], a[28:31], a[120:123], a[132:135]
    v_rcp_f32 v129, v129
    v_mfma_f32_16x16x32_bf16 a[136:139], a[32:35], a[120:123], a[136:139]
    v_rcp_f32 v130, v130
    v_mfma_f32_16x16x32_bf16 a[128:131], a[36:39], a[124:127], a[128:131]
    v_rcp_f32 v131, v131
    v_mfma_f32_16x16x32_bf16 a[132:135], a[40:43], a[124:127], a[132:135]
    v_rcp_f32 v132, v132
    v_mfma_f32_16x16x32_bf16 a[136:139], a[44:47], a[124:127], a[136:139]
    v_rcp_f32 v133, v133
    v_mfma_f32_32x32x16_bf16 v[160:175], a[24:27], v[144:147], v[160:175]
    ds_read_b64_tr_b16 a[24:25], v17 offset:6144
    ds_read_b64_tr_b16 a[26:27], v17 offset:6400
    v_rcp_f32 v134, v134
    v_rcp_f32 v135, v135
    v_rcp_f32 v136, v136
    v_mfma_f32_32x32x16_bf16 v[176:191], a[28:31], v[144:147], v[176:191]
    ds_read_b64_tr_b16 a[28:29], v17 offset:7168
    ds_read_b64_tr_b16 a[30:31], v17 offset:7424
    v_rcp_f32 v137, v137
    v_rcp_f32 v138, v138
    v_mfma_f32_32x32x16_bf16 v[192:207], a[32:35], v[144:147], v[192:207]
    ds_read_b64_tr_b16 a[32:33], v17 offset:8192
    ds_read_b64_tr_b16 a[34:35], v17 offset:8448
    v_rcp_f32 v139, v139
    v_rcp_f32 v140, v140
    v_mfma_f32_32x32x16_bf16 v[160:175], a[36:39], v[148:151], v[160:175]
    ds_read_b64_tr_b16 a[36:37], v17 offset:9216
    ds_read_b64_tr_b16 a[38:39], v17 offset:9472
    v_rcp_f32 v141, v141
    v_rcp_f32 v142, v142
    v_mfma_f32_32x32x16_bf16 v[176:191], a[40:43], v[148:151], v[176:191]
    ds_read_b64_tr_b16 a[40:41], v17 offset:10240
    ds_read_b64_tr_b16 a[42:43], v17 offset:10496
    v_rcp_f32 v143, v143
    v_exp_f32 v96, v96
    v_mfma_f32_32x32x16_bf16 v[192:207], a[44:47], v[148:151], v[192:207]
    ds_read_b64_tr_b16 a[44:45], v17 offset:11264
L_pad2:
    s_cbranch_execz L_padret
    ds_read_b64_tr_b16 a[46:47], v17 offset:11520
    v_exp_f32 v97, v97
    v_exp_f32 v98, v98
    s_waitcnt vmcnt(8)
    s_barrier
    v_mfma_f32_32x32x16_bf16 v[64:79], a[0:3], a[48:51], 0
    ds_read_b64_tr_b16 a[0:1], v12 offset:0
    ds_read_b64_tr_b16 a[2:3], v12 offset:256
    v_exp_f32 v99, v99
    v_exp_f32 v100, v100
    v_mfma_f32_32x32x16_bf16 v[64:79], a[4:7], a[52:55], v[64:79]
    ds_read_b64_tr_b16 a[4:5], v12 offset:1024
    ds_read_b64_tr_b16 a[6:7], v12 offset:1280
    v_exp_f32 v101, v101
    v_exp_f32 v102, v102
    v_mfma_f32_32x32x16_bf16 v[64:79], a[8:11], a[56:59], v[64:79]
    ds_read_b64_tr_b16 a[8:9], v12 offset:2048
    ds_read_b64_tr_b16 a[10:11], v12 offset:2304
    v_exp_f32 v103, v103
    v_exp_f32 v104, v104
    v_exp_f32 v105, v105
    v_mfma_f32_32x32x16_bf16 v[64:79], a[12:15], a[60:63], v[64:79]
    ds_read_b64_tr_b16 a[12:13], v12 offset:3072
    ds_read_b64_tr_b16 a[14:15], v12 offset:3328
    v_exp_f32 v106, v106
    v_exp_f32 v107, v107
    v_mfma_f32_32x32x16_bf16 v[64:79], a[16:19], a[64:67], v[64:79]
    ds_read_b64_tr_b16 a[16:17], v12 offset:4096
    ds_read_b64_tr_b16 a[18:19], v12 offset:4352
    v_exp_f32 v108, v108
    v_exp_f32 v109, v109
    v_mfma_f32_32x32x16_bf16 v[64:79], a[20:23], a[68:71], v[64:79]
    ds_read_b64_tr_b16 a[20:21], v12 offset:5120
    ds_read_b64_tr_b16 a[22:23], v12 offset:5376
    v_exp_f32 v110, v110
    v_exp_f32 v111, v111
    v_pk_mul_f32 v[128:129], v[80:81], v[128:129]
    v_pk_mul_f32 v[130:131], v[82:83], v[130:131]
    v_pk_mul_f32 v[132:133], v[84:85], v[132:133]
    v_pk_mul_f32 v[134:135], v[86:87], v[134:135]
    v_pk_mul_f32 v[136:137], v[88:89], v[136:137]
    v_pk_mul_f32 v[138:139], v[90:91], v[138:139]
    v_pk_mul_f32 v[140:141], v[92:93], v[140:141]
    v_pk_mul_f32 v[142:143], v[94:95], v[142:143]
    v_pk_fma_f32 v[96:97], v[96:97], s[42:43], s[42:43]
    v_pk_fma_f32 v[98:99], v[98:99], s[42:43], s[42:43]
    v_pk_fma_f32 v[100:101], v[100:101], s[42:43], s[42:43]
    v_pk_fma_f32 v[102:103], v[102:103], s[42:43], s[42:43]
    v_pk_fma_f32 v[104:105], v[104:105], s[42:43], s[42:43]
    v_pk_fma_f32 v[106:107], v[106:107], s[42:43], s[42:43]
    v_pk_fma_f32 v[108:109], v[108:109], s[42:43], s[42:43]
    v_pk_fma_f32 v[110:111], v[110:111], s[42:43], s[42:43]
    v_pk_fma_f32 v[112:113], v[64:65], v[64:65], s[40:41]
    v_pk_fma_f32 v[114:115], v[66:67], v[66:67], s[40:41]
    v_pk_fma_f32 v[116:117], v[68:69], v[68:69], s[40:41]
    v_pk_fma_f32 v[118:119], v[70:71], v[70:71], s[40:41]
    v_pk_fma_f32 v[120:121], v[72:73], v[72:73], s[40:41]
    v_pk_fma_f32 v[122:123], v[74:75], v[74:75], s[40:41]
    v_pk_fma_f32 v[124:125], v[76:77], v[76:77], s[40:41]
    v_pk_fma_f32 v[126:127], v[78:79], v[78:79], s[40:41]
    v_pk_mul_f32 v[112:113], v[64:65], v[112:113] neg_lo:[1,0] neg_hi:[1,0]
    v_pk_mul_f32 v[114:115], v[66:67], v[114:115] neg_lo:[1,0] neg_hi:[1,0]
    v_pk_mul_f32 v[116:117], v[68:69], v[116:117] neg_lo:[1,0] neg_hi:[1,0]
    v_pk_mul_f32 v[118:119], v[70:71], v[118:119] neg_lo:[1,0] neg_hi:[1,0]
    v_pk_mul_f32 v[120:121], v[72:73], v[120:121] neg_lo:[1,0] neg_hi:[1,0]
    v_pk_mul_f32 v[122:123], v[74:75], v[122:123] neg_lo:[1,0] neg_hi:[1,0]
    v_pk_mul_f32 v[124:125], v[76:77], v[124:125] neg_lo:[1,0] neg_hi:[1,0]
    v_pk_mul_f32 v[126:127], v[78:79], v[126:127] neg_lo:[1,0] neg_hi:[1,0]
    s_waitcnt lgkmcnt(0)
    v_mfma_f32_32x32x16_bf16 v[80:95], a[0:3], a[48:51], 0
    ds_read_b64_tr_b16 a[0:1], v13 offset:0
    ds_read_b64_tr_b16 a[2:3], v13 offset:256
    v_cvt_pk_bf16_f32 v144, v128, v129
    v_rcp_f32 v96, v96
    v_cvt_pk_bf16_f32 v145, v130, v131
    v_rcp_f32 v97, v97
    v_cvt_pk_bf16_f32 v146, v132, v133
    v_mfma_f32_32x32x16_bf16 v[80:95], a[4:7], a[52:55], v[80:95]
    ds_read_b64_tr_b16 a[4:5], v13 offset:1024
    ds_read_b64_tr_b16 a[6:7], v13 offset:1280
    buffer_load_dwordx4 a[164:167], v29, s[4:7], s3 offen offset:0
    v_rcp_f32 v98, v98
    v_cvt_pk_bf16_f32 v147, v134, v135
    v_rcp_f32 v99, v99
    v_mfma_f32_32x32x16_bf16 v[80:95], a[8:11], a[56:59], v[80:95]
    ds_read_b64_tr_b16 a[8:9], v13 offset:2048
    ds_read_b64_tr_b16 a[10:11], v13 offset:2304
    v_cvt_pk_bf16_f32 v148, v136, v137
    v_rcp_f32 v100, v100
    v_cvt_pk_bf16_f32 v149, v138, v139
    v_rcp_f32 v101, v101
    v_mfma_f32_32x32x16_bf16 v[80:95], a[12:15], a[60:63], v[80:95]
    ds_read_b64_tr_b16 a[12:13], v13 offset:3072
    ds_read_b64_tr_b16 a[14:15], v13 offset:3328
    v_cvt_pk_bf16_f32 v150, v140, v141
    v_rcp_f32 v102, v102
    v_cvt_pk_bf16_f32 v151, v142, v143
    v_rcp_f32 v103, v103
    v_mfma_f32_32x32x16_bf16 v[80:95], a[16:19], a[64:67], v[80:95]
    ds_read_b64_tr_b16 a[16:17], v13 offset:4096
    ds_read_b64_tr_b16 a[18:19], v13 offset:4352
    buffer_load_dwordx4 a[168:171], v29, s[4:7], s3 offen offset:64
    v_rcp_f32 v104, v104
    v_rcp_f32 v105, v105
    v_rcp_f32 v106, v106
    v_mfma_f32_32x32x16_bf16 v[80:95], a[20:23], a[68:71], v[80:95]
    ds_read_b64_tr_b16 a[20:21], v13 offset:5120
    ds_read_b64_tr_b16 a[22:23], v13 offset:5376
    v_rcp_f32 v107, v107
    v_rcp_f32 v108, v108
    v_rcp_f32 v109, v109
    v_mfma_f32_32x32x16_bf16 v[160:175], a[24:27], v[144:147], v[160:175]
    ds_read_b64_tr_b16 a[24:25], v18 offset:6144
    ds_read_b64_tr_b16 a[26:27], v18 offset:6400
    v_rcp_f32 v110, v110
    v_rcp_f32 v111, v111
    v_exp_f32 v112, v112
    v_mfma_f32_32x32x16_bf16 v[176:191], a[28:31], v[144:147], v[176:191]
    ds_read_b64_tr_b16 a[28:29], v18 offset:7168
    ds_read_b64_tr_b16 a[30:31], v18 offset:7424
    buffer_load_dwordx4 a[172:175], v29, s[4:7], s3 offen offset:128
    v_exp_f32 v113, v113
    v_exp_f32 v114, v114
    v_exp_f32 v115, v115
    v_mfma_f32_32x32x16_bf16 v[192:207], a[32:35], v[144:147], v[192:207]
    ds_read_b64_tr_b16 a[32:33], v18 offset:8192
    ds_read_b64_tr_b16 a[34:35], v18 offset:8448
    v_exp_f32 v116, v116
    v_exp_f32 v117, v117
    v_exp_f32 v118, v118
    v_mfma_f32_32x32x16_bf16 v[160:175], a[36:39], v[148:151], v[160:175]
    ds_read_b64_tr_b16 a[36:37], v18 offset:9216
    ds_read_b64_tr_b16 a[38:39], v18 offset:9472
    v_exp_f32 v119, v119
    v_exp_f32 v120, v120
    v_exp_f32 v121, v121
    v_mfma_f32_32x32x16_bf16 v[176:191], a[40:43], v[148:151], v[176:191]
    ds_read_b64_tr_b16 a[40:41], v18 offset:10240
    ds_read_b64_tr_b16 a[42:43], v18 offset:10496
    buffer_load_dwordx2 v[46:47], v30, s[4:7], 0 offen
    v_exp_f32 v122, v122
    v_exp_f32 v123, v123
    v_exp_f32 v124, v124
    v_mfma_f32_32x32x16_bf16 v[192:207], a[44:47], v[148:151], v[192:207]
    ds_read_b64_tr_b16 a[44:45], v18 offset:11264
    ds_read_b64_tr_b16 a[46:47], v18 offset:11520
    v_exp_f32 v125, v125
    v_exp_f32 v126, v126
    v_exp_f32 v127, v127
    v_pk_mul_f32 v[96:97], v[48:49], v[96:97]
    v_pk_mul_f32 v[98:99], v[50:51], v[98:99]
    v_pk_mul_f32 v[100:101], v[52:53], v[100:101]
    v_pk_mul_f32 v[102:103], v[54:55], v[102:103]
    v_pk_mul_f32 v[104:105], v[56:57], v[104:105]
    v_pk_mul_f32 v[106:107], v[58:59], v[106:107]
    v_pk_mul_f32 v[108:109], v[60:61], v[108:109]
    v_pk_mul_f32 v[110:111], v[62:63], v[110:111]
    v_pk_fma_f32 v[112:113], v[112:113], s[42:43], s[42:43]
    v_pk_fma_f32 v[114:115], v[114:115], s[42:43], s[42:43]
    v_pk_fma_f32 v[116:117], v[116:117], s[42:43], s[42:43]
    v_pk_fma_f32 v[118:119], v[118:119], s[42:43], s[42:43]
    v_pk_fma_f32 v[120:121], v[120:121], s[42:43], s[42:43]
    v_pk_fma_f32 v[122:123], v[122:123], s[42:43], s[42:43]
    v_pk_fma_f32 v[124:125], v[124:125], s[42:43], s[42:43]
    v_pk_fma_f32 v[126:127], v[126:127], s[42:43], s[42:43]
    v_pk_fma_f32 v[128:129], v[80:81], v[80:81], s[40:41]
    v_pk_fma_f32 v[130:131], v[82:83], v[82:83], s[40:41]
    v_pk_fma_f32 v[132:133], v[84:85], v[84:85], s[40:41]
    v_pk_fma_f32 v[134:135], v[86:87], v[86:87], s[40:41]
    v_pk_fma_f32 v[136:137], v[88:89], v[88:89], s[40:41]
    v_pk_fma_f32 v[138:139], v[90:91], v[90:91], s[40:41]
    v_pk_fma_f32 v[140:141], v[92:93], v[92:93], s[40:41]
    v_pk_fma_f32 v[142:143], v[94:95], v[94:95], s[40:41]
    v_pk_mul_f32 v[128:129], v[80:81], v[128:129] neg_lo:[1,0] neg_hi:[1,0]
    v_pk_mul_f32 v[130:131], v[82:83], v[130:131] neg_lo:[1,0] neg_hi:[1,0]
    v_pk_mul_f32 v[132:133], v[84:85], v[132:133] neg_lo:[1,0] neg_hi:[1,0]
    v_pk_mul_f32 v[134:135], v[86:87], v[134:135] neg_lo:[1,0] neg_hi:[1,0]
    v_pk_mul_f32 v[136:137], v[88:89], v[136:137] neg_lo:[1,0] neg_hi:[1,0]
    v_pk_mul_f32 v[138:139], v[90:91], v[138:139] neg_lo:[1,0] neg_hi:[1,0]
    v_pk_mul_f32 v[140:141], v[92:93], v[140:141] neg_lo:[1,0] neg_hi:[1,0]
    v_pk_mul_f32 v[142:143], v[94:95], v[142:143] neg_lo:[1,0] neg_hi:[1,0]
    s_waitcnt lgkmcnt(0)
    v_mfma_f32_32x32x16_bf16 v[48:63], a[0:3], a[48:51], 0
    ds_read_b64_tr_b16 a[0:1], v15 offset:0
    ds_read_b64_tr_b16 a[2:3], v15 offset:256
    v_cvt_pk_bf16_f32 v144, v96, v97
    v_rcp_f32 v112, v112
    v_cvt_pk_bf16_f32 v145, v98, v99
    v_rcp_f32 v113, v113
    v_mfma_f32_32x32x16_bf16 v[48:63], a[4:7], a[52:55], v[48:63]
    ds_read_b64_tr_b16 a[4:5], v15 offset:1024
    ds_read_b64_tr_b16 a[6:7], v15 offset:1280
    v_cvt_pk_bf16_f32 v146, v100, v101
    v_rcp_f32 v114, v114
    v_cvt_pk_bf16_f32 v147, v102, v103
    v_rcp_f32 v115, v115
    v_mfma_f32_32x32x16_bf16 v[48:63], a[8:11], a[56:59], v[48:63]
    ds_read_b64_tr_b16 a[8:9], v15 offset:2048
    ds_read_b64_tr_b16 a[10:11], v15 offset:2304
    v_cvt_pk_bf16_f32 v148, v104, v105
    v_rcp_f32 v116, v116
    v_cvt_pk_bf16_f32 v149, v106, v107
    v_rcp_f32 v117, v117
    v_mfma_f32_32x32x16_bf16 v[48:63], a[12:15], a[60:63], v[48:63]
    ds_read_b64_tr_b16 a[12:13], v15 offset:3072
    ds_read_b64_tr_b16 a[14:15], v15 offset:3328
    v_cvt_pk_bf16_f32 v150, v108, v109
    v_rcp_f32 v118, v118
    v_cvt_pk_bf16_f32 v151, v110, v111
    v_rcp_f32 v119, v119
    v_mfma_f32_32x32x16_bf16 v[48:63], a[16:19], a[64:67], v[48:63]
    ds_read_b64_tr_b16 a[16:17], v15 offset:4096
    ds_read_b64_tr_b16 a[18:19], v15 offset:4352
    v_rcp_f32 v120, v120
    v_rcp_f32 v121, v121
    v_rcp_f32 v122, v122
    v_mfma_f32_32x32x16_bf16 v[48:63], a[20:23], a[68:71], v[48:63]
    ds_read_b64_tr_b16 a[20:21], v15 offset:5120
    ds_read_b64_tr_b16 a[22:23], v15 offset:5376
    v_rcp_f32 v123, v123
    v_rcp_f32 v124, v124
    v_rcp_f32 v125, v125
    v_mfma_f32_32x32x16_bf16 v[160:175], a[24:27], v[144:147], v[160:175]
    ds_read_b64_tr_b16 a[24:25], v19 offset:6144
    ds_read_b64_tr_b16 a[26:27], v19 offset:6400
    v_rcp_f32 v126, v126
    v_rcp_f32 v127, v127
    v_exp_f32 v128, v128
    v_mfma_f32_32x32x16_bf16 v[176:191], a[28:31], v[144:147], v[176:191]
    ds_read_b64_tr_b16 a[28:29], v19 offset:7168
    ds_read_b64_tr_b16 a[30:31], v19 offset:7424
    v_exp_f32 v129, v129
    v_exp_f32 v130, v130
    v_exp_f32 v131, v131
    v_mfma_f32_32x32x16_bf16 v[192:207], a[32:35], v[144:147], v[192:207]
    ds_read_b64_tr_b16 a[32:33], v19 offset:8192
    ds_read_b64_tr_b16 a[34:35], v19 offset:8448
    v_exp_f32 v132, v132
    v_exp_f32 v133, v133
    v_exp_f32 v134, v134
    v_mfma_f32_32x32x16_bf16 v[160:175], a[36:39], v[148:151], v[160:175]
    ds_read_b64_tr_b16 a[36:37], v19 offset:9216
    ds_read_b64_tr_b16 a[38:39], v19 offset:9472
    v_exp_f32 v135, v135
    v_exp_f32 v136, v136
    v_exp_f32 v137, v137
    v_mfma_f32_32x32x16_bf16 v[176:191], a[40:43], v[148:151], v[176:191]
    ds_read_b64_tr_b16 a[40:41], v19 offset:10240
    ds_read_b64_tr_b16 a[42:43], v19 offset:10496
    v_exp_f32 v138, v138
    v_exp_f32 v139, v139
    v_exp_f32 v140, v140
    v_mfma_f32_32x32x16_bf16 v[192:207], a[44:47], v[148:151], v[192:207]
    ds_read_b64_tr_b16 a[44:45], v19 offset:11264
    ds_read_b64_tr_b16 a[46:47], v19 offset:11520
    v_exp_f32 v141, v141
    v_exp_f32 v142, v142
    v_exp_f32 v143, v143
    v_pk_mul_f32 v[112:113], v[64:65], v[112:113]
    v_pk_mul_f32 v[114:115], v[66:67], v[114:115]
    v_pk_mul_f32 v[116:117], v[68:69], v[116:117]
    v_pk_mul_f32 v[118:119], v[70:71], v[118:119]
    v_pk_mul_f32 v[120:121], v[72:73], v[120:121]
    v_pk_mul_f32 v[122:123], v[74:75], v[122:123]
    v_pk_mul_f32 v[124:125], v[76:77], v[124:125]
    v_pk_mul_f32 v[126:127], v[78:79], v[126:127]
    v_pk_fma_f32 v[128:129], v[128:129], s[42:43], s[42:43]
    v_pk_fma_f32 v[130:131], v[130:131], s[42:43], s[42:43]
    v_pk_fma_f32 v[132:133], v[132:133], s[42:43], s[42:43]
    v_pk_fma_f32 v[134:135], v[134:135], s[42:43], s[42:43]
    v_pk_fma_f32 v[136:137], v[136:137], s[42:43], s[42:43]
    v_pk_fma_f32 v[138:139], v[138:139], s[42:43], s[42:43]
    v_pk_fma_f32 v[140:141], v[140:141], s[42:43], s[42:43]
    v_pk_fma_f32 v[142:143], v[142:143], s[42:43], s[42:43]
    v_pk_fma_f32 v[96:97], v[48:49], v[48:49], s[40:41]
    v_pk_fma_f32 v[98:99], v[50:51], v[50:51], s[40:41]
    v_pk_fma_f32 v[100:101], v[52:53], v[52:53], s[40:41]
    v_pk_fma_f32 v[102:103], v[54:55], v[54:55], s[40:41]
    v_pk_fma_f32 v[104:105], v[56:57], v[56:57], s[40:41]
    v_pk_fma_f32 v[106:107], v[58:59], v[58:59], s[40:41]
    v_pk_fma_f32 v[108:109], v[60:61], v[60:61], s[40:41]
    v_pk_fma_f32 v[110:111], v[62:63], v[62:63], s[40:41]
    v_pk_mul_f32 v[96:97], v[48:49], v[96:97] neg_lo:[1,0] neg_hi:[1,0]
    v_pk_mul_f32 v[98:99], v[50:51], v[98:99] neg_lo:[1,0] neg_hi:[1,0]
    v_pk_mul_f32 v[100:101], v[52:53], v[100:101] neg_lo:[1,0] neg_hi:[1,0]
    v_pk_mul_f32 v[102:103], v[54:55], v[102:103] neg_lo:[1,0] neg_hi:[1,0]
    v_pk_mul_f32 v[104:105], v[56:57], v[104:105] neg_lo:[1,0] neg_hi:[1,0]
    v_pk_mul_f32 v[106:107], v[58:59], v[106:107] neg_lo:[1,0] neg_hi:[1,0]
    v_pk_mul_f32 v[108:109], v[60:61], v[108:109] neg_lo:[1,0] neg_hi:[1,0]
    v_pk_mul_f32 v[110:111], v[62:63], v[110:111] neg_lo:[1,0] neg_hi:[1,0]
    s_waitcnt lgkmcnt(0)
    v_mfma_f32_32x32x16_bf16 v[64:79], a[0:3], a[48:51], 0
    ds_read_b64_tr_b16 a[0:1], v14 offset:0
    ds_read_b64_tr_b16 a[2:3], v14 offset:256
    v_cvt_pk_bf16_f32 v144, v112, v113
    v_rcp_f32 v128, v128
    v_cvt_pk_bf16_f32 v145, v114, v115
    v_rcp_f32 v129, v129
    v_mfma_f32_32x32x16_bf16 v[64:79], a[4:7], a[52:55], v[64:79]
    ds_read_b64_tr_b16 a[4:5], v14 offset:1024
    ds_read_b64_tr_b16 a[6:7], v14 offset:1280
    v_cvt_pk_bf16_f32 v146, v116, v117
    v_rcp_f32 v130, v130
    v_cvt_pk_bf16_f32 v147, v118, v119
    v_rcp_f32 v131, v131
    v_mfma_f32_32x32x16_bf16 v[64:79], a[8:11], a[56:59], v[64:79]
    ds_read_b64_tr_b16 a[8:9], v14 offset:2048
    ds_read_b64_tr_b16 a[10:11], v14 offset:2304
    v_cvt_pk_bf16_f32 v148, v120, v121
    v_rcp_f32 v132, v132
    v_cvt_pk_bf16_f32 v149, v122, v123
    v_rcp_f32 v133, v133
    v_mfma_f32_32x32x16_bf16 v[64:79], a[12:15], a[60:63], v[64:79]
    ds_read_b64_tr_b16 a[12:13], v14 offset:3072
    ds_read_b64_tr_b16 a[14:15], v14 offset:3328
    v_cvt_pk_bf16_f32 v150, v124, v125
    v_rcp_f32 v134, v134
    v_cvt_pk_bf16_f32 v151, v126, v127
    v_rcp_f32 v135, v135
    v_mfma_f32_32x32x16_bf16 v[64:79], a[16:19], a[64:67], v[64:79]
    ds_read_b64_tr_b16 a[16:17], v14 offset:4096
    ds_read_b64_tr_b16 a[18:19], v14 offset:4352
    v_rcp_f32 v136, v136
    v_rcp_f32 v137, v137
    v_rcp_f32 v138, v138
    v_mfma_f32_32x32x16_bf16 v[64:79], a[20:23], a[68:71], v[64:79]
    ds_read_b64_tr_b16 a[20:21], v14 offset:5120
    ds_read_b64_tr_b16 a[22:23], v14 offset:5376
    v_rcp_f32 v139, v139
    v_rcp_f32 v140, v140
    v_rcp_f32 v141, v141
    v_mfma_f32_32x32x16_bf16 v[160:175], a[24:27], v[144:147], v[160:175]
    ds_read_b64_tr_b16 a[24:25], v12 offset:6144
    ds_read_b64_tr_b16 a[26:27], v12 offset:6400
    v_rcp_f32 v142, v142
    v_rcp_f32 v143, v143
    v_exp_f32 v96, v96
    v_mfma_f32_32x32x16_bf16 v[176:191], a[28:31], v[144:147], v[176:191]
    ds_read_b64_tr_b16 a[28:29], v12 offset:7168
    ds_read_b64_tr_b16 a[30:31], v12 offset:7424
    v_exp_f32 v97, v97
    v_exp_f32 v98, v98
    v_exp_f32 v99, v99
    v_mfma_f32_32x32x16_bf16 v[192:207], a[32:35], v[144:147], v[192:207]
    ds_read_b64_tr_b16 a[32:33], v12 offset:8192
    ds_read_b64_tr_b16 a[34:35], v12 offset:8448
    v_exp_f32 v100, v100
    v_exp_f32 v101, v101
    v_exp_f32 v102, v102
    v_mfma_f32_32x32x16_bf16 v[160:175], a[36:39], v[148:151], v[160:175]
    ds_read_b64_tr_b16 a[36:37], v12 offset:9216
    ds_read_b64_tr_b16 a[38:39], v12 offset:9472
    v_exp_f32 v103, v103
    v_exp_f32 v104, v104
    v_exp_f32 v105, v105
    v_mfma_f32_32x32x16_bf16 v[176:191], a[40:43], v[148:151], v[176:191]
    ds_read_b64_tr_b16 a[40:41], v12 offset:10240
    ds_read_b64_tr_b16 a[42:43], v12 offset:10496
    v_exp_f32 v106, v106
    v_exp_f32 v107, v107
    v_exp_f32 v108, v108
    v_mfma_f32_32x32x16_bf16 v[192:207], a[44:47], v[148:151], v[192:207]
    ds_read_b64_tr_b16 a[44:45], v12 offset:11264
    ds_read_b64_tr_b16 a[46:47], v12 offset:11520
    v_exp_f32 v109, v109
    v_exp_f32 v110, v110
    v_exp_f32 v111, v111
    v_pk_mul_f32 v[128:129], v[80:81], v[128:129]
    v_pk_mul_f32 v[130:131], v[82:83], v[130:131]
    v_pk_mul_f32 v[132:133], v[84:85], v[132:133]
    v_pk_mul_f32 v[134:135], v[86:87], v[134:135]
    v_pk_mul_f32 v[136:137], v[88:89], v[136:137]
    v_pk_mul_f32 v[138:139], v[90:91], v[138:139]
    v_pk_mul_f32 v[140:141], v[92:93], v[140:141]
    v_pk_mul_f32 v[142:143], v[94:95], v[142:143]
    v_pk_fma_f32 v[96:97], v[96:97], s[42:43], s[42:43]
    v_pk_fma_f32 v[98:99], v[98:99], s[42:43], s[42:43]
    v_pk_fma_f32 v[100:101], v[100:101], s[42:43], s[42:43]
    v_pk_fma_f32 v[102:103], v[102:103], s[42:43], s[42:43]
    v_pk_fma_f32 v[104:105], v[104:105], s[42:43], s[42:43]
    v_pk_fma_f32 v[106:107], v[106:107], s[42:43], s[42:43]
    v_pk_fma_f32 v[108:109], v[108:109], s[42:43], s[42:43]
    v_pk_fma_f32 v[110:111], v[110:111], s[42:43], s[42:43]
    v_pk_fma_f32 v[112:113], v[64:65], v[64:65], s[40:41]
    v_pk_fma_f32 v[114:115], v[66:67], v[66:67], s[40:41]
    v_pk_fma_f32 v[116:117], v[68:69], v[68:69], s[40:41]
    v_pk_fma_f32 v[118:119], v[70:71], v[70:71], s[40:41]
    v_pk_fma_f32 v[120:121], v[72:73], v[72:73], s[40:41]
    v_pk_fma_f32 v[122:123], v[74:75], v[74:75], s[40:41]
    v_pk_fma_f32 v[124:125], v[76:77], v[76:77], s[40:41]
    v_pk_fma_f32 v[126:127], v[78:79], v[78:79], s[40:41]
    v_pk_mul_f32 v[112:113], v[64:65], v[112:113] neg_lo:[1,0] neg_hi:[1,0]
    v_pk_mul_f32 v[114:115], v[66:67], v[114:115] neg_lo:[1,0] neg_hi:[1,0]
    v_pk_mul_f32 v[116:117], v[68:69], v[116:117] neg_lo:[1,0] neg_hi:[1,0]
    v_pk_mul_f32 v[118:119], v[70:71], v[118:119] neg_lo:[1,0] neg_hi:[1,0]
    v_pk_mul_f32 v[120:121], v[72:73], v[120:121] neg_lo:[1,0] neg_hi:[1,0]
    v_pk_mul_f32 v[122:123], v[74:75], v[122:123] neg_lo:[1,0] neg_hi:[1,0]
    v_pk_mul_f32 v[124:125], v[76:77], v[124:125] neg_lo:[1,0] neg_hi:[1,0]
    v_pk_mul_f32 v[126:127], v[78:79], v[126:127] neg_lo:[1,0] neg_hi:[1,0]
    s_waitcnt vmcnt(4) lgkmcnt(0)
    v_mfma_f32_16x16x32_bf16 v[152:155], a[0:3], a[96:99], 0
    v_cvt_pk_bf16_f32 v144, v128, v129
    v_rcp_f32 v96, v96
    v_mfma_f32_16x16x32_bf16 v[152:155], a[4:7], a[100:103], v[152:155]
    v_cvt_pk_bf16_f32 v145, v130, v131
    v_mfma_f32_16x16x32_bf16 v[152:155], a[8:11], a[104:107], v[152:155]
    v_rcp_f32 v97, v97
    v_mfma_f32_16x16x32_bf16 v[152:155], a[12:15], a[108:111], v[152:155]
    v_cvt_pk_bf16_f32 v146, v132, v133
    v_rcp_f32 v98, v98
    v_mfma_f32_16x16x32_bf16 v[152:155], a[16:19], a[112:115], v[152:155]
    v_cvt_pk_bf16_f32 v147, v134, v135
    v_mfma_f32_16x16x32_bf16 v[152:155], a[20:23], a[116:119], v[152:155]
    v_rcp_f32 v99, v99
    v_mfma_f32_32x32x16_bf16 v[80:95], a[0:3], a[48:51], 0
    v_cvt_pk_bf16_f32 v148, v136, v137
    v_rcp_f32 v100, v100
    v_cvt_pk_bf16_f32 v149, v138, v139
    v_rcp_f32 v101, v101
    v_mfma_f32_32x32x16_bf16 v[80:95], a[4:7], a[52:55], v[80:95]
    v_cvt_pk_bf16_f32 v150, v140, v141
    v_rcp_f32 v102, v102
    v_cvt_pk_bf16_f32 v151, v142, v143
    v_rcp_f32 v103, v103
    v_mfma_f32_32x32x16_bf16 v[80:95], a[8:11], a[56:59], v[80:95]
    v_rcp_f32 v104, v104
    v_rcp_f32 v105, v105
    v_rcp_f32 v106, v106
    v_mfma_f32_32x32x16_bf16 v[80:95], a[12:15], a[60:63], v[80:95]
    v_rcp_f32 v107, v107
    v_rcp_f32 v108, v108
    v_rcp_f32 v109, v109
    v_mfma_f32_32x32x16_bf16 v[80:95], a[16:19], a[64:67], v[80:95]
    v_rcp_f32 v110, v110
    v_rcp_f32 v111, v111
    v_exp_f32 v112, v112
    v_mfma_f32_32x32x16_bf16 v[80:95], a[20:23], a[68:71], v[80:95]
    v_exp_f32 v113, v113
    v_exp_f32 v114, v114
    v_exp_f32 v115, v115
    v_mfma_f32_32x32x16_bf16 v[160:175], v[4:7], a[140:143], v[160:175]
    v_exp_f32 v116, v116
    v_exp_f32 v117, v117
    v_exp_f32 v118, v118
    v_mfma_f32_32x32x16_bf16 v[160:175], v[8:11], a[144:147], v[160:175]
    v_exp_f32 v119, v119
    v_exp_f32 v120, v120
    v_exp_f32 v121, v121
    v_mfma_f32_32x32x16_bf16 v[160:175], a[24:27], v[144:147], v[160:175]
    ds_read_b64_tr_b16 a[24:25], v13 offset:6144
    ds_read_b64_tr_b16 a[26:27], v13 offset:6400
    v_exp_f32 v122, v122
    v_exp_f32 v123, v123
    v_mfma_f32_32x32x16_bf16 v[176:191], a[28:31], v[144:147], v[176:191]
    ds_read_b64_tr_b16 a[28:29], v13 offset:7168
    ds_read_b64_tr_b16 a[30:31], v13 offset:7424
    v_exp_f32 v124, v124
    v_exp_f32 v125, v125
    v_mfma_f32_32x32x16_bf16 v[192:207], a[32:35], v[144:147], v[192:207]
    ds_read_b64_tr_b16 a[32:33], v13 offset:8192
    ds_read_b64_tr_b16 a[34:35], v13 offset:8448
    v_exp_f32 v126, v126
    v_exp_f32 v127, v127
    v_mfma_f32_32x32x16_bf16 v[160:175], a[36:39], v[148:151], v[160:175]
    ds_read_b64_tr_b16 a[36:37], v13 offset:9216
    ds_read_b64_tr_b16 a[38:39], v13 offset:9472
    v_mfma_f32_32x32x16_bf16 v[176:191], a[40:43], v[148:151], v[176:191]
    ds_read_b64_tr_b16 a[40:41], v13 offset:10240
    ds_read_b64_tr_b16 a[42:43], v13 offset:10496
    v_mfma_f32_32x32x16_bf16 v[192:207], a[44:47], v[148:151], v[192:207]
    ds_read_b64_tr_b16 a[44:45], v13 offset:11264
    ds_read_b64_tr_b16 a[46:47], v13 offset:11520
    v_pk_mul_f32 v[96:97], v[48:49], v[96:97]
    v_pk_mul_f32 v[98:99], v[50:51], v[98:99]
    v_pk_mul_f32 v[100:101], v[52:53], v[100:101]
    v_pk_mul_f32 v[102:103], v[54:55], v[102:103]
    v_pk_mul_f32 v[104:105], v[56:57], v[104:105]
    v_pk_mul_f32 v[106:107], v[58:59], v[106:107]
    v_pk_mul_f32 v[108:109], v[60:61], v[108:109]
    v_pk_mul_f32 v[110:111], v[62:63], v[110:111]
    v_pk_fma_f32 v[112:113], v[112:113], s[42:43], s[42:43]
    v_pk_fma_f32 v[114:115], v[114:115], s[42:43], s[42:43]
    v_pk_fma_f32 v[116:117], v[116:117], s[42:43], s[42:43]
    v_pk_fma_f32 v[118:119], v[118:119], s[42:43], s[42:43]
    v_pk_fma_f32 v[120:121], v[120:121], s[42:43], s[42:43]
    v_pk_fma_f32 v[122:123], v[122:123], s[42:43], s[42:43]
    v_pk_fma_f32 v[124:125], v[124:125], s[42:43], s[42:43]
    v_pk_fma_f32 v[126:127], v[126:127], s[42:43], s[42:43]
    v_pk_fma_f32 v[128:129], v[80:81], v[80:81], s[40:41]
    v_pk_fma_f32 v[130:131], v[82:83], v[82:83], s[40:41]
    v_pk_fma_f32 v[132:133], v[84:85], v[84:85], s[40:41]
    v_pk_fma_f32 v[134:135], v[86:87], v[86:87], s[40:41]
    v_pk_fma_f32 v[136:137], v[88:89], v[88:89], s[40:41]
    v_pk_fma_f32 v[138:139], v[90:91], v[90:91], s[40:41]
    v_pk_fma_f32 v[140:141], v[92:93], v[92:93], s[40:41]
    v_pk_fma_f32 v[142:143], v[94:95], v[94:95], s[40:41]
    v_pk_mul_f32 v[128:129], v[80:81], v[128:129] neg_lo:[1,0] neg_hi:[1,0]
    v_pk_mul_f32 v[130:131], v[82:83], v[130:131] neg_lo:[1,0] neg_hi:[1,0]
    v_pk_mul_f32 v[132:133], v[84:85], v[132:133] neg_lo:[1,0] neg_hi:[1,0]
    v_pk_mul_f32 v[134:135], v[86:87], v[134:135] neg_lo:[1,0] neg_hi:[1,0]
    v_pk_mul_f32 v[136:137], v[88:89], v[136:137] neg_lo:[1,0] neg_hi:[1,0]
    v_pk_mul_f32 v[138:139], v[90:91], v[138:139] neg_lo:[1,0] neg_hi:[1,0]
    v_pk_mul_f32 v[140:141], v[92:93], v[140:141] neg_lo:[1,0] neg_hi:[1,0]
    v_pk_mul_f32 v[142:143], v[94:95], v[142:143] neg_lo:[1,0] neg_hi:[1,0]
    v_pk_fma_f32 v[156:157], v[152:153], v[152:153], s[40:41]
    v_pk_fma_f32 v[158:159], v[154:155], v[154:155], s[40:41]
    v_pk_mul_f32 v[156:157], v[152:153], v[156:157] neg_lo:[1,0] neg_hi:[1,0]
    v_pk_mul_f32 v[158:159], v[154:155], v[158:159] neg_lo:[1,0] neg_hi:[1,0]
    s_waitcnt lgkmcnt(0)
    v_mfma_f32_32x32x16_bf16 v[48:63], a[0:3], a[72:75], 0
    ds_read_b64_tr_b16 a[0:1], v18 offset:0
    ds_read_b64_tr_b16 a[2:3], v18 offset:256
    v_cvt_pk_bf16_f32 v144, v96, v97
    v_rcp_f32 v112, v112
    v_cvt_pk_bf16_f32 v145, v98, v99
    v_rcp_f32 v113, v113
    v_mfma_f32_32x32x16_bf16 v[48:63], a[4:7], a[76:79], v[48:63]
    ds_read_b64_tr_b16 a[4:5], v18 offset:1024
    ds_read_b64_tr_b16 a[6:7], v18 offset:1280
    v_cvt_pk_bf16_f32 v146, v100, v101
    v_rcp_f32 v114, v114
    v_cvt_pk_bf16_f32 v147, v102, v103
    v_mfma_f32_32x32x16_bf16 v[48:63], a[8:11], a[80:83], v[48:63]
    ds_read_b64_tr_b16 a[8:9], v18 offset:2048
    ds_read_b64_tr_b16 a[10:11], v18 offset:2304
    v_rcp_f32 v115, v115
    v_cvt_pk_bf16_f32 v148, v104, v105
    v_rcp_f32 v116, v116
    v_cvt_pk_bf16_f32 v149, v106, v107
    v_mfma_f32_32x32x16_bf16 v[48:63], a[12:15], a[84:87], v[48:63]
    ds_read_b64_tr_b16 a[12:13], v18 offset:3072
    ds_read_b64_tr_b16 a[14:15], v18 offset:3328
    v_rcp_f32 v117, v117
    v_cvt_pk_bf16_f32 v150, v108, v109
    v_rcp_f32 v118, v118
    v_cvt_pk_bf16_f32 v151, v110, v111
    v_mfma_f32_32x32x16_bf16 v[48:63], a[16:19], a[88:91], v[48:63]
    ds_read_b64_tr_b16 a[16:17], v18 offset:4096
    ds_read_b64_tr_b16 a[18:19], v18 offset:4352
    v_rcp_f32 v119, v119
    v_rcp_f32 v120, v120
    v_rcp_f32 v121, v121
    v_mfma_f32_32x32x16_bf16 v[48:63], a[20:23], a[92:95], v[48:63]
    ds_read_b64_tr_b16 a[20:21], v18 offset:5120
    ds_read_b64_tr_b16 a[22:23], v18 offset:5376
    v_rcp_f32 v122, v122
    v_rcp_f32 v123, v123
    v_mfma_f32_32x32x16_bf16 v[176:191], v[4:7], a[148:151], v[176:191]
    v_rcp_f32 v124, v124
    v_rcp_f32 v125, v125
    v_rcp_f32 v126, v126
    v_rcp_f32 v127, v127
    v_mfma_f32_32x32x16_bf16 v[176:191], v[8:11], a[152:155], v[176:191]
    v_exp_f32 v128, v128
    v_exp_f32 v129, v129
    v_exp_f32 v130, v130
    v_exp_f32 v131, v131
    v_mfma_f32_32x32x16_bf16 v[160:175], a[24:27], v[144:147], v[160:175]
    ds_read_b64_tr_b16 a[24:25], v15 offset:6144
    ds_read_b64_tr_b16 a[26:27], v15 offset:6400
    v_exp_f32 v132, v132
    v_exp_f32 v133, v133
    v_mfma_f32_32x32x16_bf16 v[176:191], a[28:31], v[144:147], v[176:191]
    ds_read_b64_tr_b16 a[28:29], v15 offset:7168
    ds_read_b64_tr_b16 a[30:31], v15 offset:7424
    v_exp_f32 v134, v134
    v_exp_f32 v135, v135
    v_exp_f32 v136, v136
    v_mfma_f32_32x32x16_bf16 v[192:207], a[32:35], v[144:147], v[192:207]
    ds_read_b64_tr_b16 a[32:33], v15 offset:8192
    ds_read_b64_tr_b16 a[34:35], v15 offset:8448
    v_exp_f32 v137, v137
    v_exp_f32 v138, v138
    v_exp_f32 v139, v139
    v_mfma_f32_32x32x16_bf16 v[160:175], a[36:39], v[148:151], v[160:175]
    ds_read_b64_tr_b16 a[36:37], v15 offset:9216
    ds_read_b64_tr_b16 a[38:39], v15 offset:9472
    v_exp_f32 v140, v140
    v_exp_f32 v141, v141
    v_exp_f32 v142, v142
    v_mfma_f32_32x32x16_bf16 v[176:191], a[40:43], v[148:151], v[176:191]
    ds_read_b64_tr_b16 a[40:41], v15 offset:10240
    ds_read_b64_tr_b16 a[42:43], v15 offset:10496
    v_exp_f32 v143, v143
    v_exp_f32 v156, v156
    v_mfma_f32_32x32x16_bf16 v[192:207], a[44:47], v[148:151], v[192:207]
    ds_read_b64_tr_b16 a[44:45], v15 offset:11264
    ds_read_b64_tr_b16 a[46:47], v15 offset:11520
    v_exp_f32 v157, v157
    v_exp_f32 v158, v158
    v_exp_f32 v159, v159
    v_pk_mul_f32 v[112:113], v[64:65], v[112:113]
    v_pk_mul_f32 v[114:115], v[66:67], v[114:115]
    v_pk_mul_f32 v[116:117], v[68:69], v[116:117]
    v_pk_mul_f32 v[118:119], v[70:71], v[118:119]
    v_pk_mul_f32 v[120:121], v[72:73], v[120:121]
    v_pk_mul_f32 v[122:123], v[74:75], v[122:123]
    v_pk_mul_f32 v[124:125], v[76:77], v[124:125]
    v_pk_mul_f32 v[126:127], v[78:79], v[126:127]
    v_pk_fma_f32 v[128:129], v[128:129], s[42:43], s[42:43]
    v_pk_fma_f32 v[130:131], v[130:131], s[42:43], s[42:43]
    v_pk_fma_f32 v[132:133], v[132:133], s[42:43], s[42:43]
    v_pk_fma_f32 v[134:135], v[134:135], s[42:43], s[42:43]
    v_pk_fma_f32 v[136:137], v[136:137], s[42:43], s[42:43]
L_pad3:
    s_cbranch_execz L_padret
    v_pk_fma_f32 v[138:139], v[138:139], s[42:43], s[42:43]
    v_pk_fma_f32 v[140:141], v[140:141], s[42:43], s[42:43]
    v_pk_fma_f32 v[142:143], v[142:143], s[42:43], s[42:43]
    v_pk_fma_f32 v[96:97], v[48:49], v[48:49], s[40:41]
    v_pk_fma_f32 v[98:99], v[50:51], v[50:51], s[40:41]
    v_pk_fma_f32 v[100:101], v[52:53], v[52:53], s[40:41]
    v_pk_fma_f32 v[102:103], v[54:55], v[54:55], s[40:41]
    v_pk_fma_f32 v[104:105], v[56:57], v[56:57], s[40:41]
    v_pk_fma_f32 v[106:107], v[58:59], v[58:59], s[40:41]
    v_pk_fma_f32 v[108:109], v[60:61], v[60:61], s[40:41]
    v_pk_fma_f32 v[110:111], v[62:63], v[62:63], s[40:41]
    v_pk_mul_f32 v[96:97], v[48:49], v[96:97] neg_lo:[1,0] neg_hi:[1,0]
    v_pk_mul_f32 v[98:99], v[50:51], v[98:99] neg_lo:[1,0] neg_hi:[1,0]
    v_pk_mul_f32 v[100:101], v[52:53], v[100:101] neg_lo:[1,0] neg_hi:[1,0]
    v_pk_mul_f32 v[102:103], v[54:55], v[102:103] neg_lo:[1,0] neg_hi:[1,0]
    v_pk_mul_f32 v[104:105], v[56:57], v[104:105] neg_lo:[1,0] neg_hi:[1,0]
    v_pk_mul_f32 v[106:107], v[58:59], v[106:107] neg_lo:[1,0] neg_hi:[1,0]
    v_pk_mul_f32 v[108:109], v[60:61], v[108:109] neg_lo:[1,0] neg_hi:[1,0]
    v_pk_mul_f32 v[110:111], v[62:63], v[110:111] neg_lo:[1,0] neg_hi:[1,0]
    v_pk_fma_f32 v[156:157], v[156:157], s[42:43], s[42:43]
    v_pk_fma_f32 v[158:159], v[158:159], s[42:43], s[42:43]
    s_waitcnt lgkmcnt(0)
    v_mfma_f32_32x32x16_bf16 v[64:79], a[0:3], a[72:75], 0
    ds_read_b64_tr_b16 a[0:1], v12 offset:0
    ds_read_b64_tr_b16 a[2:3], v12 offset:256
    v_cvt_pk_bf16_f32 v144, v112, v113
    v_rcp_f32 v128, v128
    v_cvt_pk_bf16_f32 v145, v114, v115
    v_rcp_f32 v129, v129
    v_mfma_f32_32x32x16_bf16 v[64:79], a[4:7], a[76:79], v[64:79]
    ds_read_b64_tr_b16 a[4:5], v12 offset:1024
    ds_read_b64_tr_b16 a[6:7], v12 offset:1280
    v_cvt_pk_bf16_f32 v146, v116, v117
    v_rcp_f32 v130, v130
    v_cvt_pk_bf16_f32 v147, v118, v119
    v_mfma_f32_32x32x16_bf16 v[64:79], a[8:11], a[80:83], v[64:79]
    ds_read_b64_tr_b16 a[8:9], v12 offset:2048
    ds_read_b64_tr_b16 a[10:11], v12 offset:2304
    v_rcp_f32 v131, v131
    v_cvt_pk_bf16_f32 v148, v120, v121
    v_rcp_f32 v132, v132
    v_cvt_pk_bf16_f32 v149, v122, v123
    v_mfma_f32_32x32x16_bf16 v[64:79], a[12:15], a[84:87], v[64:79]
    ds_read_b64_tr_b16 a[12:13], v12 offset:3072
    ds_read_b64_tr_b16 a[14:15], v12 offset:3328
    v_rcp_f32 v133, v133
    v_cvt_pk_bf16_f32 v150, v124, v125
    v_rcp_f32 v134, v134
    v_cvt_pk_bf16_f32 v151, v126, v127
    v_mfma_f32_32x32x16_bf16 v[64:79], a[16:19], a[88:91], v[64:79]
    ds_read_b64_tr_b16 a[16:17], v12 offset:4096
    ds_read_b64_tr_b16 a[18:19], v12 offset:4352
    v_rcp_f32 v135, v135
    v_rcp_f32 v136, v136
    v_rcp_f32 v137, v137
    v_mfma_f32_32x32x16_bf16 v[64:79], a[20:23], a[92:95], v[64:79]
    ds_read_b64_tr_b16 a[20:21], v12 offset:5120
    ds_read_b64_tr_b16 a[22:23], v12 offset:5376
    v_rcp_f32 v138, v138
    v_rcp_f32 v139, v139
    v_mfma_f32_32x32x16_bf16 v[192:207], v[4:7], a[156:159], v[192:207]
    v_rcp_f32 v140, v140
    v_rcp_f32 v141, v141
    v_rcp_f32 v142, v142
    v_rcp_f32 v143, v143
    v_mfma_f32_32x32x16_bf16 v[192:207], v[8:11], a[160:163], v[192:207]
    v_rcp_f32 v156, v156
    v_rcp_f32 v157, v157
    v_rcp_f32 v158, v158
    v_rcp_f32 v159, v159
    v_mfma_f32_32x32x16_bf16 v[160:175], a[24:27], v[144:147], v[160:175]
    ds_read_b64_tr_b16 a[24:25], v14 offset:6144
    ds_read_b64_tr_b16 a[26:27], v14 offset:6400
    v_exp_f32 v96, v96
    v_exp_f32 v97, v97
    v_mfma_f32_32x32x16_bf16 v[176:191], a[28:31], v[144:147], v[176:191]
    ds_read_b64_tr_b16 a[28:29], v14 offset:7168
    ds_read_b64_tr_b16 a[30:31], v14 offset:7424
    v_exp_f32 v98, v98
    v_exp_f32 v99, v99
    v_exp_f32 v100, v100
    v_mfma_f32_32x32x16_bf16 v[192:207], a[32:35], v[144:147], v[192:207]
    ds_read_b64_tr_b16 a[32:33], v14 offset:8192
    ds_read_b64_tr_b16 a[34:35], v14 offset:8448
    v_exp_f32 v101, v101
    v_exp_f32 v102, v102
    v_exp_f32 v103, v103
    v_mfma_f32_32x32x16_bf16 v[160:175], a[36:39], v[148:151], v[160:175]
    ds_read_b64_tr_b16 a[36:37], v14 offset:9216
    ds_read_b64_tr_b16 a[38:39], v14 offset:9472
    v_exp_f32 v104, v104
    v_exp_f32 v105, v105
    v_exp_f32 v106, v106
    v_mfma_f32_32x32x16_bf16 v[176:191], a[40:43], v[148:151], v[176:191]
    ds_read_b64_tr_b16 a[40:41], v14 offset:10240
    ds_read_b64_tr_b16 a[42:43], v14 offset:10496
    v_exp_f32 v107, v107
    v_exp_f32 v108, v108
    v_mfma_f32_32x32x16_bf16 v[192:207], a[44:47], v[148:151], v[192:207]
    ds_read_b64_tr_b16 a[44:45], v14 offset:11264
    ds_read_b64_tr_b16 a[46:47], v14 offset:11520
    v_exp_f32 v109, v109
    v_exp_f32 v110, v110
    v_exp_f32 v111, v111
    v_pk_mul_f32 v[128:129], v[80:81], v[128:129]
    v_pk_mul_f32 v[130:131], v[82:83], v[130:131]
    v_pk_mul_f32 v[132:133], v[84:85], v[132:133]
    v_pk_mul_f32 v[134:135], v[86:87], v[134:135]
    v_pk_mul_f32 v[136:137], v[88:89], v[136:137]
    v_pk_mul_f32 v[138:139], v[90:91], v[138:139]
    v_pk_mul_f32 v[140:141], v[92:93], v[140:141]
    v_pk_mul_f32 v[142:143], v[94:95], v[142:143]
    v_pk_fma_f32 v[96:97], v[96:97], s[42:43], s[42:43]
    v_pk_fma_f32 v[98:99], v[98:99], s[42:43], s[42:43]
    v_pk_fma_f32 v[100:101], v[100:101], s[42:43], s[42:43]
    v_pk_fma_f32 v[102:103], v[102:103], s[42:43], s[42:43]
    v_pk_fma_f32 v[104:105], v[104:105], s[42:43], s[42:43]
    v_pk_fma_f32 v[106:107], v[106:107], s[42:43], s[42:43]
    v_pk_fma_f32 v[108:109], v[108:109], s[42:43], s[42:43]
    v_pk_fma_f32 v[110:111], v[110:111], s[42:43], s[42:43]
    v_pk_fma_f32 v[112:113], v[64:65], v[64:65], s[40:41]
    v_pk_fma_f32 v[114:115], v[66:67], v[66:67], s[40:41]
    v_pk_fma_f32 v[116:117], v[68:69], v[68:69], s[40:41]
    v_pk_fma_f32 v[118:119], v[70:71], v[70:71], s[40:41]
    v_pk_fma_f32 v[120:121], v[72:73], v[72:73], s[40:41]
    v_pk_fma_f32 v[122:123], v[74:75], v[74:75], s[40:41]
    v_pk_fma_f32 v[124:125], v[76:77], v[76:77], s[40:41]
    v_pk_fma_f32 v[126:127], v[78:79], v[78:79], s[40:41]
    v_pk_mul_f32 v[112:113], v[64:65], v[112:113] neg_lo:[1,0] neg_hi:[1,0]
    v_pk_mul_f32 v[114:115], v[66:67], v[114:115] neg_lo:[1,0] neg_hi:[1,0]
    v_pk_mul_f32 v[116:117], v[68:69], v[116:117] neg_lo:[1,0] neg_hi:[1,0]
    v_pk_mul_f32 v[118:119], v[70:71], v[118:119] neg_lo:[1,0] neg_hi:[1,0]
    v_pk_mul_f32 v[120:121], v[72:73], v[120:121] neg_lo:[1,0] neg_hi:[1,0]
    v_pk_mul_f32 v[122:123], v[74:75], v[122:123] neg_lo:[1,0] neg_hi:[1,0]
    v_pk_mul_f32 v[124:125], v[76:77], v[124:125] neg_lo:[1,0] neg_hi:[1,0]
    v_pk_mul_f32 v[126:127], v[78:79], v[126:127] neg_lo:[1,0] neg_hi:[1,0]
    v_pk_mul_f32 v[156:157], v[152:153], v[156:157]
    v_pk_mul_f32 v[158:159], v[154:155], v[158:159]
    s_waitcnt vmcnt(0) lgkmcnt(0)
    v_mfma_f32_32x32x16_bf16 v[80:95], a[0:3], a[72:75], 0
    v_cvt_pk_bf16_f32 v144, v128, v129
    v_rcp_f32 v96, v96
    v_cvt_pk_bf16_f32 v145, v130, v131
    v_rcp_f32 v97, v97
    v_mfma_f32_32x32x16_bf16 v[80:95], a[4:7], a[76:79], v[80:95]
    v_cvt_pk_bf16_f32 v146, v132, v133
    v_rcp_f32 v98, v98
    v_cvt_pk_bf16_f32 v147, v134, v135
    v_rcp_f32 v99, v99
    v_mfma_f32_32x32x16_bf16 v[80:95], a[8:11], a[80:83], v[80:95]
    v_cvt_pk_bf16_f32 v148, v136, v137
    v_rcp_f32 v100, v100
    v_cvt_pk_bf16_f32 v149, v138, v139
    v_rcp_f32 v101, v101
    v_mfma_f32_32x32x16_bf16 v[80:95], a[12:15], a[84:87], v[80:95]
    v_cvt_pk_bf16_f32 v150, v140, v141
    v_rcp_f32 v102, v102
    v_cvt_pk_bf16_f32 v151, v142, v143
    v_rcp_f32 v103, v103
    v_mfma_f32_32x32x16_bf16 v[80:95], a[16:19], a[88:91], v[80:95]
    v_cvt_pk_bf16_f32 v2, v156, v157
    v_rcp_f32 v104, v104
    v_cvt_pk_bf16_f32 v3, v158, v159
    v_rcp_f32 v105, v105
    v_mfma_f32_32x32x16_bf16 v[80:95], a[20:23], a[92:95], v[80:95]
    s_mov_b64 exec, s[44:45]
    s_nop 0
    ds_write_b64 v35, v[2:3]
    s_mov_b64 exec, -1
    ds_read_b128 a[120:123], v36
    ds_read_b128 a[124:127], v36 offset:128
    v_mfma_f32_32x32x16_bf16 v[208:223], v[4:7], a[164:167], v[208:223]
    v_rcp_f32 v106, v106
    v_rcp_f32 v107, v107
    v_mfma_f32_32x32x16_bf16 v[224:239], v[4:7], a[168:171], v[224:239]
    v_rcp_f32 v108, v108
    v_rcp_f32 v109, v109
    v_rcp_f32 v110, v110
    v_mfma_f32_32x32x16_bf16 v[240:255], v[4:7], a[172:175], v[240:255]
    v_rcp_f32 v111, v111
    v_exp_f32 v112, v112
    v_exp_f32 v113, v113
    v_mfma_f32_32x32x16_bf16 v[160:175], a[24:27], v[144:147], v[160:175]
    v_exp_f32 v114, v114
    v_exp_f32 v115, v115
    v_exp_f32 v116, v116
    v_mfma_f32_32x32x16_bf16 v[176:191], a[28:31], v[144:147], v[176:191]
    v_exp_f32 v117, v117
    v_exp_f32 v118, v118
    v_exp_f32 v119, v119
    v_mfma_f32_32x32x16_bf16 v[192:207], a[32:35], v[144:147], v[192:207]
    v_exp_f32 v120, v120
    v_exp_f32 v121, v121
    v_exp_f32 v122, v122
    v_mfma_f32_32x32x16_bf16 v[160:175], a[36:39], v[148:151], v[160:175]
    v_exp_f32 v123, v123
    v_exp_f32 v124, v124
    v_exp_f32 v125, v125
    v_mfma_f32_32x32x16_bf16 v[176:191], a[40:43], v[148:151], v[176:191]
    v_exp_f32 v126, v126
    v_exp_f32 v127, v127
    v_mfma_f32_32x32x16_bf16 v[192:207], a[44:47], v[148:151], v[192:207]
    v_pk_mul_f32 v[96:97], v[48:49], v[96:97]
    v_pk_mul_f32 v[98:99], v[50:51], v[98:99]
    v_pk_mul_f32 v[100:101], v[52:53], v[100:101]
    v_pk_mul_f32 v[102:103], v[54:55], v[102:103]
    v_pk_mul_f32 v[104:105], v[56:57], v[104:105]
    v_pk_mul_f32 v[106:107], v[58:59], v[106:107]
    v_pk_mul_f32 v[108:109], v[60:61], v[108:109]
    v_pk_mul_f32 v[110:111], v[62:63], v[110:111]
    v_pk_fma_f32 v[112:113], v[112:113], s[42:43], s[42:43]
    v_pk_fma_f32 v[114:115], v[114:115], s[42:43], s[42:43]
    v_pk_fma_f32 v[116:117], v[116:117], s[42:43], s[42:43]
    v_pk_fma_f32 v[118:119], v[118:119], s[42:43], s[42:43]
    v_pk_fma_f32 v[120:121], v[120:121], s[42:43], s[42:43]
    v_pk_fma_f32 v[122:123], v[122:123], s[42:43], s[42:43]
    v_pk_fma_f32 v[124:125], v[124:125], s[42:43], s[42:43]
    v_pk_fma_f32 v[126:127], v[126:127], s[42:43], s[42:43]
    v_pk_fma_f32 v[128:129], v[80:81], v[80:81], s[40:41]
    v_pk_fma_f32 v[130:131], v[82:83], v[82:83], s[40:41]
    v_pk_fma_f32 v[132:133], v[84:85], v[84:85], s[40:41]
    v_pk_fma_f32 v[134:135], v[86:87], v[86:87], s[40:41]
    v_pk_fma_f32 v[136:137], v[88:89], v[88:89], s[40:41]
    v_pk_fma_f32 v[138:139], v[90:91], v[90:91], s[40:41]
    v_pk_fma_f32 v[140:141], v[92:93], v[92:93], s[40:41]
    v_pk_fma_f32 v[142:143], v[94:95], v[94:95], s[40:41]
    v_pk_mul_f32 v[128:129], v[80:81], v[128:129] neg_lo:[1,0] neg_hi:[1,0]
    v_pk_mul_f32 v[130:131], v[82:83], v[130:131] neg_lo:[1,0] neg_hi:[1,0]
    v_pk_mul_f32 v[132:133], v[84:85], v[132:133] neg_lo:[1,0] neg_hi:[1,0]
    v_pk_mul_f32 v[134:135], v[86:87], v[134:135] neg_lo:[1,0] neg_hi:[1,0]
    v_pk_mul_f32 v[136:137], v[88:89], v[136:137] neg_lo:[1,0] neg_hi:[1,0]
    v_pk_mul_f32 v[138:139], v[90:91], v[138:139] neg_lo:[1,0] neg_hi:[1,0]
    v_pk_mul_f32 v[140:141], v[92:93], v[140:141] neg_lo:[1,0] neg_hi:[1,0]
    v_pk_mul_f32 v[142:143], v[94:95], v[142:143] neg_lo:[1,0] neg_hi:[1,0]
    v_cvt_pk_bf16_f32 v144, v96, v97
    v_cvt_pk_bf16_f32 v145, v98, v99
    v_cvt_pk_bf16_f32 v146, v100, v101
    v_cvt_pk_bf16_f32 v147, v102, v103
    v_cvt_pk_bf16_f32 v148, v104, v105
    v_cvt_pk_bf16_f32 v149, v106, v107
    v_cvt_pk_bf16_f32 v150, v108, v109
    v_cvt_pk_bf16_f32 v151, v110, v111
    s_waitcnt lgkmcnt(0)
    v_mfma_f32_16x16x32_bf16 a[128:131], a[24:27], a[120:123], a[128:131]
    v_cvt_pk_bf16_f32 v175, v174, v175
    v_cvt_pk_bf16_f32 v174, v172, v173
    v_cvt_pk_bf16_f32 v172, v164, v165
    v_cvt_pk_bf16_f32 v173, v166, v167
    v_cvt_pk_bf16_f32 v171, v170, v171
    v_cvt_pk_bf16_f32 v170, v168, v169
    v_cvt_pk_bf16_f32 v168, v160, v161
    v_cvt_pk_bf16_f32 v169, v162, v163
    v_mfma_f32_16x16x32_bf16 a[132:135], a[28:31], a[120:123], a[132:135]
    v_permlane32_swap_b32 v172, v174
    v_permlane32_swap_b32 v173, v175
    v_permlane32_swap_b32 v168, v170
    v_permlane32_swap_b32 v169, v171
    v_rcp_f32 v112, v112
    v_cndmask_b32_dpp v160, v172, v168, vcc quad_perm:[0,0,2,2] row_mask:0xf bank_mask:0xf
    v_mfma_f32_16x16x32_bf16 a[136:139], a[32:35], a[120:123], a[136:139]
    v_cndmask_b32_dpp v161, v173, v169, vcc quad_perm:[0,0,2,2] row_mask:0xf bank_mask:0xf
    v_cndmask_b32_dpp v162, v174, v170, vcc quad_perm:[0,0,2,2] row_mask:0xf bank_mask:0xf
    v_cndmask_b32_dpp v163, v175, v171, vcc quad_perm:[0,0,2,2] row_mask:0xf bank_mask:0xf
    v_rcp_f32 v113, v113
    buffer_store_dwordx4 v[160:163], v40, s[20:23], 0 offen offset:0 sc0 sc1
    v_rcp_f32 v114, v114
    v_mfma_f32_16x16x32_bf16 a[128:131], a[36:39], a[124:127], a[128:131]
    v_rcp_f32 v115, v115
    v_rcp_f32 v116, v116
    s_not_b64 vcc, vcc
    v_cndmask_b32_dpp v164, v168, v172, vcc quad_perm:[1,1,3,3] row_mask:0xf bank_mask:0xf
    v_cndmask_b32_dpp v165, v169, v173, vcc quad_perm:[1,1,3,3] row_mask:0xf bank_mask:0xf
    v_mfma_f32_16x16x32_bf16 a[132:135], a[40:43], a[124:127], a[132:135]
    v_cndmask_b32_dpp v166, v170, v174, vcc quad_perm:[1,1,3,3] row_mask:0xf bank_mask:0xf
    v_cndmask_b32_dpp v167, v171, v175, vcc quad_perm:[1,1,3,3] row_mask:0xf bank_mask:0xf
    v_rcp_f32 v117, v117
    buffer_store_dwordx4 v[164:167], v41, s[20:23], 0 offen offset:0 sc0 sc1
    v_rcp_f32 v118, v118
    v_mfma_f32_16x16x32_bf16 a[136:139], a[44:47], a[124:127], a[136:139]
    v_rcp_f32 v119, v119
    v_rcp_f32 v120, v120
    v_rcp_f32 v121, v121
    v_cvt_pk_bf16_f32 v187, v186, v187
    v_mfma_f32_32x32x16_bf16 v[208:223], a[24:27], v[144:147], v[208:223]
    ds_read_b64_tr_b16 a[24:25], v18 offset:6144
    ds_read_b64_tr_b16 a[26:27], v18 offset:6400
    v_cvt_pk_bf16_f32 v186, v184, v185
    v_cvt_pk_bf16_f32 v184, v176, v177
    v_cvt_pk_bf16_f32 v185, v178, v179
    v_cvt_pk_bf16_f32 v191, v190, v191
    v_cvt_pk_bf16_f32 v190, v188, v189
    v_cvt_pk_bf16_f32 v188, v180, v181
    v_cvt_pk_bf16_f32 v189, v182, v183
    v_permlane32_swap_b32 v184, v186
    v_permlane32_swap_b32 v185, v187
    v_permlane32_swap_b32 v188, v190
    v_permlane32_swap_b32 v189, v191
    v_rcp_f32 v122, v122
    v_cndmask_b32_dpp v180, v184, v188, vcc quad_perm:[1,1,3,3] row_mask:0xf bank_mask:0xf
    v_cndmask_b32_dpp v181, v185, v189, vcc quad_perm:[1,1,3,3] row_mask:0xf bank_mask:0xf
    v_cndmask_b32_dpp v182, v186, v190, vcc quad_perm:[1,1,3,3] row_mask:0xf bank_mask:0xf
    v_mfma_f32_32x32x16_bf16 v[224:239], a[28:31], v[144:147], v[224:239]
    ds_read_b64_tr_b16 a[28:29], v18 offset:7168
    ds_read_b64_tr_b16 a[30:31], v18 offset:7424
    v_cndmask_b32_dpp v183, v187, v191, vcc quad_perm:[1,1,3,3] row_mask:0xf bank_mask:0xf
    v_rcp_f32 v123, v123
    buffer_store_dwordx4 v[180:183], v41, s[20:23], 0 offen offset:64 sc0 sc1
    v_rcp_f32 v124, v124
    v_rcp_f32 v125, v125
    v_rcp_f32 v126, v126
    v_rcp_f32 v127, v127
    s_not_b64 vcc, vcc
    v_cndmask_b32_dpp v176, v188, v184, vcc quad_perm:[0,0,2,2] row_mask:0xf bank_mask:0xf
    v_mfma_f32_32x32x16_bf16 v[240:255], a[32:35], v[144:147], v[240:255]
    ds_read_b64_tr_b16 a[32:33], v18 offset:8192
    ds_read_b64_tr_b16 a[34:35], v18 offset:8448
    v_cndmask_b32_dpp v177, v189, v185, vcc quad_perm:[0,0,2,2] row_mask:0xf bank_mask:0xf
    v_cndmask_b32_dpp v178, v190, v186, vcc quad_perm:[0,0,2,2] row_mask:0xf bank_mask:0xf
    v_cndmask_b32_dpp v179, v191, v187, vcc quad_perm:[0,0,2,2] row_mask:0xf bank_mask:0xf
    v_exp_f32 v128, v128
    buffer_store_dwordx4 v[176:179], v40, s[20:23], 0 offen offset:64 sc0 sc1
    v_exp_f32 v129, v129
    v_exp_f32 v130, v130
    v_exp_f32 v131, v131
    v_exp_f32 v132, v132
    v_cvt_pk_bf16_f32 v207, v206, v207
    v_mfma_f32_32x32x16_bf16 v[208:223], a[36:39], v[148:151], v[208:223]
    ds_read_b64_tr_b16 a[36:37], v18 offset:9216
    ds_read_b64_tr_b16 a[38:39], v18 offset:9472
    v_cvt_pk_bf16_f32 v206, v204, v205
    v_cvt_pk_bf16_f32 v204, v196, v197
    v_cvt_pk_bf16_f32 v205, v198, v199
    v_cvt_pk_bf16_f32 v203, v202, v203
    v_cvt_pk_bf16_f32 v202, v200, v201
    v_cvt_pk_bf16_f32 v200, v192, v193
    v_cvt_pk_bf16_f32 v201, v194, v195
    v_permlane32_swap_b32 v204, v206
    v_permlane32_swap_b32 v205, v207
    v_permlane32_swap_b32 v200, v202
    v_permlane32_swap_b32 v201, v203
    v_exp_f32 v133, v133
    v_cndmask_b32_dpp v192, v204, v200, vcc quad_perm:[0,0,2,2] row_mask:0xf bank_mask:0xf
    v_cndmask_b32_dpp v193, v205, v201, vcc quad_perm:[0,0,2,2] row_mask:0xf bank_mask:0xf
    v_mfma_f32_32x32x16_bf16 v[224:239], a[40:43], v[148:151], v[224:239]
    ds_read_b64_tr_b16 a[40:41], v18 offset:10240
    ds_read_b64_tr_b16 a[42:43], v18 offset:10496
    v_cndmask_b32_dpp v194, v206, v202, vcc quad_perm:[0,0,2,2] row_mask:0xf bank_mask:0xf
    v_cndmask_b32_dpp v195, v207, v203, vcc quad_perm:[0,0,2,2] row_mask:0xf bank_mask:0xf
    v_exp_f32 v134, v134
    buffer_store_dwordx4 v[192:195], v40, s[20:23], 0 offen offset:128 sc0 sc1
    v_exp_f32 v135, v135
    v_exp_f32 v136, v136
    v_exp_f32 v137, v137
    s_not_b64 vcc, vcc
    v_cndmask_b32_dpp v196, v200, v204, vcc quad_perm:[1,1,3,3] row_mask:0xf bank_mask:0xf
    v_cndmask_b32_dpp v197, v201, v205, vcc quad_perm:[1,1,3,3] row_mask:0xf bank_mask:0xf
    v_cndmask_b32_dpp v198, v202, v206, vcc quad_perm:[1,1,3,3] row_mask:0xf bank_mask:0xf
    v_mfma_f32_32x32x16_bf16 v[240:255], a[44:47], v[148:151], v[240:255]
    ds_read_b64_tr_b16 a[44:45], v18 offset:11264
    ds_read_b64_tr_b16 a[46:47], v18 offset:11520
    v_cndmask_b32_dpp v199, v203, v207, vcc quad_perm:[1,1,3,3] row_mask:0xf bank_mask:0xf
    v_exp_f32 v138, v138
    buffer_store_dwordx4 v[196:199], v41, s[20:23], 0 offen offset:128 sc0 sc1
    v_exp_f32 v139, v139
    v_exp_f32 v140, v140
    v_exp_f32 v141, v141
    v_exp_f32 v142, v142
    v_exp_f32 v143, v143
    v_pk_mul_f32 v[112:113], v[64:65], v[112:113]
    v_pk_mul_f32 v[114:115], v[66:67], v[114:115]
    v_pk_mul_f32 v[116:117], v[68:69], v[116:117]
    v_pk_mul_f32 v[118:119], v[70:71], v[118:119]
    v_pk_mul_f32 v[120:121], v[72:73], v[120:121]
    v_pk_mul_f32 v[122:123], v[74:75], v[122:123]
    v_pk_mul_f32 v[124:125], v[76:77], v[124:125]
    v_pk_mul_f32 v[126:127], v[78:79], v[126:127]
    v_pk_fma_f32 v[128:129], v[128:129], s[42:43], s[42:43]
    v_pk_fma_f32 v[130:131], v[130:131], s[42:43], s[42:43]
    v_pk_fma_f32 v[132:133], v[132:133], s[42:43], s[42:43]
    v_pk_fma_f32 v[134:135], v[134:135], s[42:43], s[42:43]
    v_pk_fma_f32 v[136:137], v[136:137], s[42:43], s[42:43]
    v_pk_fma_f32 v[138:139], v[138:139], s[42:43], s[42:43]
    v_pk_fma_f32 v[140:141], v[140:141], s[42:43], s[42:43]
    v_pk_fma_f32 v[142:143], v[142:143], s[42:43], s[42:43]
    v_cvt_pk_bf16_f32 v144, v112, v113
    v_cvt_pk_bf16_f32 v145, v114, v115
    v_cvt_pk_bf16_f32 v146, v116, v117
    v_cvt_pk_bf16_f32 v147, v118, v119
    v_cvt_pk_bf16_f32 v148, v120, v121
    v_cvt_pk_bf16_f32 v149, v122, v123
    v_cvt_pk_bf16_f32 v150, v124, v125
    v_cvt_pk_bf16_f32 v151, v126, v127
    s_waitcnt lgkmcnt(0)
    v_mfma_f32_32x32x16_bf16 v[208:223], a[24:27], v[144:147], v[208:223]
    ds_read_b64_tr_b16 a[24:25], v12 offset:6144
    ds_read_b64_tr_b16 a[26:27], v12 offset:6400
    v_rcp_f32 v128, v128
    v_rcp_f32 v129, v129
    v_rcp_f32 v130, v130
    v_mfma_f32_32x32x16_bf16 v[224:239], a[28:31], v[144:147], v[224:239]
    ds_read_b64_tr_b16 a[28:29], v12 offset:7168
    ds_read_b64_tr_b16 a[30:31], v12 offset:7424
    ds_write_b128 v37, a[128:131] offset:6144
    v_rcp_f32 v131, v131
    v_rcp_f32 v132, v132
    v_mfma_f32_32x32x16_bf16 v[240:255], a[32:35], v[144:147], v[240:255]
    ds_read_b64_tr_b16 a[32:33], v12 offset:8192
    ds_read_b64_tr_b16 a[34:35], v12 offset:8448
    v_rcp_f32 v133, v133
    v_rcp_f32 v134, v134
    v_rcp_f32 v135, v135
    v_rcp_f32 v136, v136
    v_mfma_f32_32x32x16_bf16 v[208:223], a[36:39], v[148:151], v[208:223]
    ds_read_b64_tr_b16 a[36:37], v12 offset:9216
    ds_read_b64_tr_b16 a[38:39], v12 offset:9472
    ds_write_b128 v37, a[132:135] offset:7168
    v_rcp_f32 v137, v137
    v_rcp_f32 v138, v138
    v_mfma_f32_32x32x16_bf16 v[224:239], a[40:43], v[148:151], v[224:239]
    ds_read_b64_tr_b16 a[40:41], v12 offset:10240
    ds_read_b64_tr_b16 a[42:43], v12 offset:10496
    v_rcp_f32 v139, v139
    v_rcp_f32 v140, v140
    v_rcp_f32 v141, v141
    v_mfma_f32_32x32x16_bf16 v[240:255], a[44:47], v[148:151], v[240:255]
    ds_read_b64_tr_b16 a[44:45], v12 offset:11264
    ds_read_b64_tr_b16 a[46:47], v12 offset:11520
    ds_write_b128 v37, a[136:139] offset:8192
    v_rcp_f32 v142, v142
    v_rcp_f32 v143, v143
    v_pk_mul_f32 v[128:129], v[80:81], v[128:129]
    v_pk_mul_f32 v[130:131], v[82:83], v[130:131]
    v_pk_mul_f32 v[132:133], v[84:85], v[132:133]
    v_pk_mul_f32 v[134:135], v[86:87], v[134:135]
    v_pk_mul_f32 v[136:137], v[88:89], v[136:137]
    v_pk_mul_f32 v[138:139], v[90:91], v[138:139]
    v_pk_mul_f32 v[140:141], v[92:93], v[140:141]
    v_pk_mul_f32 v[142:143], v[94:95], v[142:143]
    v_cvt_pk_bf16_f32 v144, v128, v129
    v_cvt_pk_bf16_f32 v145, v130, v131
    v_cvt_pk_bf16_f32 v146, v132, v133
    v_cvt_pk_bf16_f32 v147, v134, v135
    v_cvt_pk_bf16_f32 v148, v136, v137
    v_cvt_pk_bf16_f32 v149, v138, v139
    v_cvt_pk_bf16_f32 v150, v140, v141
    v_cvt_pk_bf16_f32 v151, v142, v143
    s_waitcnt lgkmcnt(0)
    s_cmp_eq_u32 s31, 1
    s_cbranch_scc1 L_m18b
    v_mfma_f32_32x32x16_bf16 v[240:255], a[32:35], v[144:147], v[240:255]
    v_mfma_f32_32x32x16_bf16 v[240:255], a[44:47], v[148:151], v[240:255]
    v_mfma_f32_32x32x16_bf16 v[224:239], a[28:31], v[144:147], v[224:239]
    v_mfma_f32_32x32x16_bf16 v[224:239], a[40:43], v[148:151], v[224:239]
    v_mfma_f32_32x32x16_bf16 v[208:223], a[24:27], v[144:147], v[208:223]
    ds_write_b128 v37, v[240:243] offset:0
    ds_write_b128 v37, v[244:247] offset:1024
    v_mfma_f32_32x32x16_bf16 v[208:223], a[36:39], v[148:151], v[208:223]
    ds_write_b128 v37, v[248:251] offset:2048
    ds_write_b128 v37, v[252:255] offset:3072
    ds_write_b128 v37, v[232:235] offset:4096
    ds_write_b128 v37, v[236:239] offset:5120
    s_branch L_m18e
L_m18b:
    v_mfma_f32_32x32x16_bf16 v[208:223], a[24:27], v[144:147], v[208:223]
    v_mfma_f32_32x32x16_bf16 v[208:223], a[36:39], v[148:151], v[208:223]
    v_mfma_f32_32x32x16_bf16 v[224:239], a[28:31], v[144:147], v[224:239]
    v_mfma_f32_32x32x16_bf16 v[224:239], a[40:43], v[148:151], v[224:239]
    v_mfma_f32_32x32x16_bf16 v[240:255], a[32:35], v[144:147], v[240:255]
    ds_write_b128 v37, v[208:211] offset:0
    ds_write_b128 v37, v[212:215] offset:1024
    v_mfma_f32_32x32x16_bf16 v[240:255], a[44:47], v[148:151], v[240:255]
    ds_write_b128 v37, v[216:219] offset:2048
    ds_write_b128 v37, v[220:223] offset:3072
    ds_write_b128 v37, v[224:227] offset:4096
    ds_write_b128 v37, v[228:231] offset:5120
L_m18e:
    s_waitcnt lgkmcnt(0)
    s_barrier
    ds_read_b128 v[48:51], v38 offset:0
    ds_read_b128 v[52:55], v38 offset:1024
    ds_read_b128 v[56:59], v38 offset:2048
    ds_read_b128 v[60:63], v38 offset:3072
    ds_read_b128 v[64:67], v38 offset:4096
    ds_read_b128 v[68:71], v38 offset:5120
    ds_read_b128 v[96:99], v39 offset:0
    ds_read_b128 v[100:103], v39 offset:9216
    ds_read_b128 v[104:107], v39 offset:18432
    ds_read_b128 v[108:111], v39 offset:27648
    s_waitcnt lgkmcnt(4)
    s_cmp_eq_u32 s31, 1
    s_cbranch_scc1 L_add1
    v_pk_add_f32 v[48:49], v[48:49], v[208:209]
    v_pk_add_f32 v[50:51], v[50:51], v[210:211]
    v_pk_add_f32 v[52:53], v[52:53], v[212:213]
    v_pk_add_f32 v[54:55], v[54:55], v[214:215]
    v_pk_add_f32 v[56:57], v[56:57], v[216:217]
    v_pk_add_f32 v[58:59], v[58:59], v[218:219]
    v_pk_add_f32 v[60:61], v[60:61], v[220:221]
    v_pk_add_f32 v[62:63], v[62:63], v[222:223]
    v_pk_add_f32 v[64:65], v[64:65], v[224:225]
    v_pk_add_f32 v[66:67], v[66:67], v[226:227]
    v_pk_add_f32 v[68:69], v[68:69], v[228:229]
    v_pk_add_f32 v[70:71], v[70:71], v[230:231]
    s_branch L_add2
L_add1:
    v_pk_add_f32 v[48:49], v[48:49], v[240:241]
    v_pk_add_f32 v[50:51], v[50:51], v[242:243]
    v_pk_add_f32 v[52:53], v[52:53], v[244:245]
    v_pk_add_f32 v[54:55], v[54:55], v[246:247]
    v_pk_add_f32 v[56:57], v[56:57], v[248:249]
    v_pk_add_f32 v[58:59], v[58:59], v[250:251]
    v_pk_add_f32 v[60:61], v[60:61], v[252:253]
    v_pk_add_f32 v[62:63], v[62:63], v[254:255]
    v_pk_add_f32 v[64:65], v[64:65], v[232:233]
    v_pk_add_f32 v[66:67], v[66:67], v[234:235]
    v_pk_add_f32 v[68:69], v[68:69], v[236:237]
    v_pk_add_f32 v[70:71], v[70:71], v[238:239]
L_add2:
    v_cvt_pk_bf16_f32 v59, v58, v59
    v_cvt_pk_bf16_f32 v58, v56, v57
    v_cvt_pk_bf16_f32 v56, v48, v49
    v_cvt_pk_bf16_f32 v57, v50, v51
    v_cvt_pk_bf16_f32 v63, v62, v63
    v_cvt_pk_bf16_f32 v62, v60, v61
    v_cvt_pk_bf16_f32 v60, v52, v53
    v_cvt_pk_bf16_f32 v61, v54, v55
    v_permlane32_swap_b32 v56, v58
    v_permlane32_swap_b32 v57, v59
    v_permlane32_swap_b32 v60, v62
    v_permlane32_swap_b32 v61, v63
    v_cvt_pk_bf16_f32 v80, v64, v65
    v_cndmask_b32_dpp v52, v56, v60, vcc quad_perm:[1,1,3,3] row_mask:0xf bank_mask:0xf
    v_cndmask_b32_dpp v53, v57, v61, vcc quad_perm:[1,1,3,3] row_mask:0xf bank_mask:0xf
    v_cndmask_b32_dpp v54, v58, v62, vcc quad_perm:[1,1,3,3] row_mask:0xf bank_mask:0xf
    v_cndmask_b32_dpp v55, v59, v63, vcc quad_perm:[1,1,3,3] row_mask:0xf bank_mask:0xf
    v_cvt_pk_bf16_f32 v81, v66, v67
    buffer_store_dwordx4 v[52:55], v43, s[20:23], s38 offen offset:0
    s_not_b64 vcc, vcc
    v_cndmask_b32_dpp v48, v60, v56, vcc quad_perm:[0,0,2,2] row_mask:0xf bank_mask:0xf
    v_cndmask_b32_dpp v49, v61, v57, vcc quad_perm:[0,0,2,2] row_mask:0xf bank_mask:0xf
    v_cndmask_b32_dpp v50, v62, v58, vcc quad_perm:[0,0,2,2] row_mask:0xf bank_mask:0xf
    v_cndmask_b32_dpp v51, v63, v59, vcc quad_perm:[0,0,2,2] row_mask:0xf bank_mask:0xf
    v_cvt_pk_bf16_f32 v82, v68, v69
    v_cvt_pk_bf16_f32 v83, v70, v71
    buffer_store_dwordx4 v[48:51], v42, s[20:23], s38 offen offset:0
    v_permlane32_swap_b32 v80, v82
    v_permlane32_swap_b32 v81, v83
    s_nop 0
    buffer_store_dwordx4 v[80:83], v29, s[20:23], s39 offen offset:0
    s_waitcnt lgkmcnt(0)
    v_pk_add_f32 v[96:97], v[96:97], v[100:101]
    v_pk_add_f32 v[104:105], v[104:105], v[108:109]
    v_lshlrev_b32 v100, 16, v46
    v_and_b32 v101, s53, v46
    v_pk_add_f32 v[98:99], v[98:99], v[102:103]
    v_pk_add_f32 v[106:107], v[106:107], v[110:111]
    v_lshlrev_b32 v102, 16, v47
    v_and_b32 v103, s53, v47
    v_pk_add_f32 v[96:97], v[96:97], v[104:105]
    v_pk_add_f32 v[98:99], v[98:99], v[106:107]
    v_pk_add_f32 v[96:97], v[96:97], v[100:101]
    v_pk_add_f32 v[98:99], v[98:99], v[102:103]
    v_cvt_pk_bf16_f32 v2, v96, v97
    v_cvt_pk_bf16_f32 v3, v98, v99
    buffer_store_dwordx2 v[2:3], v30, s[20:23], 0 offen
L_end:
    s_endpgm
L_code_end:
.p2align 7
L_tab:
    .long 0x31e631b0, 0x31c2321c, 0x31b031e6, 0x31b031b0, 0x31e831b2, 0x31c3321e, 0x320e31e7, 0x320e320e
    .long 0x31ea31b4, 0x31bc3220, 0x326c31e0, 0x326c326c, 0x31ec31b6, 0x31bd3222, 0x32ca31e1, 0x32ca32ca
    .long 0x31ee31b8, 0x31c83224, 0x332831ec, 0x33283328, 0x31f031ba, 0x31c93226, 0x338631ed, 0x33863386
    .long 0x31f231bc, 0x31c23228, 0x33e431e6, 0x33e433e4, 0x31f431be, 0x31c3322a, 0x344231e7, 0x34423442
    .long 0x31f631c0, 0x31ce322c, 0x31b131f2, 0x31cc31b1, 0x31f831c2, 0x31cf322e, 0x320f31f3, 0x322a320f
    .long 0x31fa31c4, 0x31c83230, 0x326d31ec, 0x3288326d, 0x31fc31c6, 0x31c93232, 0x32cb31ed, 0x32e632cb
    .long 0x31fe31c8, 0x31d43234, 0x332931f8, 0x33443329, 0x320031ca, 0x31d53236, 0x338731f9, 0x33a23387
    .long 0x320231cc, 0x31ce3238, 0x33e531f2, 0x340033e5, 0x320431ce, 0x31cf323a, 0x344331f3, 0x345e3443
    .long 0x320631d0, 0x31b6323c, 0x31b23222, 0x31ce31b8, 0x320831d2, 0x31b7323e, 0x32103223, 0x322c3216
    .long 0x320a31d4, 0x31b03240, 0x326e321c, 0x328a3274, 0x320c31d6, 0x31b13254, 0x32cc321d, 0x32e832d2
    .long 0x322031d8, 0x31bc3256, 0x332a3228, 0x33463330, 0x322231ec, 0x31bd3258, 0x33883229, 0x33a4338e
    .long 0x322431ee, 0x31b6325a, 0x33e63222, 0x340233ec, 0x322631f0, 0x31b7325c, 0x34443223, 0x3460344a
    .long 0x322831f2, 0x31c2325e, 0x31b3322e, 0x31d031b9, 0x322a31f4, 0x31c33260, 0x3211322f, 0x322e3217
    .long 0x322c31f6, 0x31bc3262, 0x326f3228, 0x328c3275, 0x322e31f8, 0x31bd3264, 0x32cd3229, 0x32ea32d3
    .long 0x323031fa, 0x31c83266, 0x332b3234, 0x33483331, 0x323231fc, 0x31c93268, 0x33893235, 0x33a6338f
    .long 0x323431fe, 0x31c2326a, 0x33e7322e, 0x340433ed, 0x32363200, 0x31c3326c, 0x3445322f, 0x3462344b
    .long 0x32383202, 0x31da326e, 0x31b4325e, 0x31d231c0, 0x323a3204, 0x31db3270, 0x3212325f, 0x3230321e
    .long 0x323c3206, 0x31d43272, 0x32703258, 0x328e327c, 0x323e3208, 0x31d53274, 0x32ce3259, 0x32ec32da
    .long 0x3240320a, 0x31e03276, 0x332c3264, 0x334a3338, 0x3242320c, 0x31e13278, 0x338a3265, 0x33a83396
    .long 0x3244320e, 0x31da327a, 0x33e8325e, 0x340633f4, 0x32463210, 0x31db327c, 0x3446325f, 0x34643452
    .long 0x32483212, 0x31e63290, 0x31b5326a, 0x31d431c1, 0x325c3214, 0x31e73292, 0x3213326b, 0x3232321f
    .long 0x325e3228, 0x31e03294, 0x32713264, 0x3290327d, 0x3260322a, 0x31e13296, 0x32cf3265, 0x32ee32db
    .long 0x3262322c, 0x31ec3298, 0x332d3270, 0x334c3339, 0x3264322e, 0x31ed329a, 0x338b3271, 0x33aa3397
    .long 0x32663230, 0x31e6329c, 0x33e9326a, 0x340833f5, 0x32683232, 0x31e7329e, 0x3447326b, 0x34663453
    .long 0x326a3234, 0x31ce32a0, 0x31b6329a, 0x31d631c8, 0x326c3236, 0x31cf32a2, 0x3214329b, 0x32343226
    .long 0x326e3238, 0x31c832a4, 0x32723294, 0x32923284, 0x3270323a, 0x31c932a6, 0x32d03295, 0x32f032e2
    .long 0x3272323c, 0x31d432a8, 0x332e32a0, 0x334e3340, 0x3274323e, 0x31d532aa, 0x338c32a1, 0x33ac339e
    .long 0x32763240, 0x31ce32ac, 0x33ea329a, 0x340a33fc, 0x32783242, 0x31cf32ae, 0x3448329b, 0x3468345a
    .long 0x327a3244, 0x31da32b0, 0x31b732a6, 0x31d831c9, 0x327c3246, 0x31db32b2, 0x321532a7, 0x32363227
    .long 0x327e3248, 0x31d432b4, 0x327332a0, 0x32943285, 0x3280324a, 0x31d532b6, 0x32d132a1, 0x32f232e3
    .long 0x3282324c, 0x31e032b8, 0x332f32ac, 0x33503341, 0x3284324e, 0x31e132cc, 0x338d32ad, 0x33ae339f
    .long 0x32983250, 0x31da32ce, 0x33eb32a6, 0x340c33fd, 0x329a3264, 0x31db32d0, 0x344932a7, 0x346a345b
    .long 0x34d634a0, 0x34b2350c, 0x34a034d6, 0x34a034a0, 0x34d834a2, 0x34b3350e, 0x34fe34d7, 0x34fe34fe
    .long 0x34da34a4, 0x34ac3510, 0x355c34d0, 0x355c355c, 0x34dc34a6, 0x34ad3512, 0x35ba34d1, 0x35ba35ba
    .long 0x34de34a8, 0x34b83514, 0x361834dc, 0x36183618, 0x34e034aa, 0x34b93516, 0x367634dd, 0x36763676
    .long 0x34e234ac, 0x34b23518, 0x36d434d6, 0x36d436d4, 0x34e434ae, 0x34b3351a, 0x373234d7, 0x37323732
    .long 0x34e634b0, 0x34be351c, 0x34a134e2, 0x34bc34a1, 0x34e834b2, 0x34bf351e, 0x34ff34e3, 0x351a34ff
    .long 0x34ea34b4, 0x34b83520, 0x355d34dc, 0x3578355d, 0x34ec34b6, 0x34b93522, 0x35bb34dd, 0x35d635bb
    .long 0x34ee34b8, 0x34c43524, 0x361934e8, 0x36343619, 0x34f034ba, 0x34c53526, 0x367734e9, 0x36923677
    .long 0x34f234bc, 0x34be3528, 0x36d534e2, 0x36f036d5, 0x34f434be, 0x34bf352a, 0x373334e3, 0x374e3733
    .long 0x34f634c0, 0x34a6352c, 0x34a23512, 0x34be34a8, 0x34f834c2, 0x34a7352e, 0x35003513, 0x351c3506
    .long 0x34fa34c4, 0x34a03530, 0x355e350c, 0x357a3564, 0x34fc34c6, 0x34a13544, 0x35bc350d, 0x35d835c2
    .long 0x351034c8, 0x34ac3546, 0x361a3518, 0x36363620, 0x351234dc, 0x34ad3548, 0x36783519, 0x3694367e
    .long 0x351434de, 0x34a6354a, 0x36d63512, 0x36f236dc, 0x351634e0, 0x34a7354c, 0x37343513, 0x3750373a
    .long 0x351834e2, 0x34b2354e, 0x34a3351e, 0x34c034a9, 0x351a34e4, 0x34b33550, 0x3501351f, 0x351e3507
    .long 0x351c34e6, 0x34ac3552, 0x355f3518, 0x357c3565, 0x351e34e8, 0x34ad3554, 0x35bd3519, 0x35da35c3
    .long 0x352034ea, 0x34b83556, 0x361b3524, 0x36383621, 0x352234ec, 0x34b93558, 0x36793525, 0x3696367f
    .long 0x352434ee, 0x34b2355a, 0x36d7351e, 0x36f436dd, 0x352634f0, 0x34b3355c, 0x3735351f, 0x3752373b
    .long 0x352834f2, 0x34ca355e, 0x34a4354e, 0x34c234b0, 0x352a34f4, 0x34cb3560, 0x3502354f, 0x3520350e
    .long 0x352c34f6, 0x34c43562, 0x35603548, 0x357e356c, 0x352e34f8, 0x34c53564, 0x35be3549, 0x35dc35ca
    .long 0x353034fa, 0x34d03566, 0x361c3554, 0x363a3628, 0x353234fc, 0x34d13568, 0x367a3555, 0x36983686
    .long 0x353434fe, 0x34ca356a, 0x36d8354e, 0x36f636e4, 0x35363500, 0x34cb356c, 0x3736354f, 0x37543742
    .long 0x35383502, 0x34d63580, 0x34a5355a, 0x34c434b1, 0x354c3504, 0x34d73582, 0x3503355b, 0x3522350f
    .long 0x354e3518, 0x34d03584, 0x35613554, 0x3580356d, 0x3550351a, 0x34d13586, 0x35bf3555, 0x35de35cb
    .long 0x3552351c, 0x34dc3588, 0x361d3560, 0x363c3629, 0x3554351e, 0x34dd358a, 0x367b3561, 0x369a3687
    .long 0x35563520, 0x34d6358c, 0x36d9355a, 0x36f836e5, 0x35583522, 0x34d7358e, 0x3737355b, 0x37563743
    .long 0x355a3524, 0x34be3590, 0x34a6358a, 0x34c634b8, 0x355c3526, 0x34bf3592, 0x3504358b, 0x35243516
    .long 0x355e3528, 0x34b83594, 0x35623584, 0x35823574, 0x3560352a, 0x34b93596, 0x35c03585, 0x35e035d2
    .long 0x3562352c, 0x34c43598, 0x361e3590, 0x363e3630, 0x3564352e, 0x34c5359a, 0x367c3591, 0x369c368e
    .long 0x35663530, 0x34be359c, 0x36da358a, 0x36fa36ec, 0x35683532, 0x34bf359e, 0x3738358b, 0x3758374a
    .long 0x356a3534, 0x34ca35a0, 0x34a73596, 0x34c834b9, 0x356c3536, 0x34cb35a2, 0x35053597, 0x35263517
    .long 0x356e3538, 0x34c435a4, 0x35633590, 0x35843575, 0x3570353a, 0x34c535a6, 0x35c13591, 0x35e235d3
    .long 0x3572353c, 0x34d035a8, 0x361f359c, 0x36403631, 0x3574353e, 0x34d135bc, 0x367d359d, 0x369e368f
    .long 0x35883540, 0x34ca35be, 0x36db3596, 0x36fc36ed, 0x358a3554, 0x34cb35c0, 0x37393597, 0x375a374b
    .long 0x37c63790, 0x37a237fc, 0x379037c6, 0x37903790, 0x37c83792, 0x37a337fe, 0x37ee37c7, 0x37ee37ee
    .long 0x37ca3794, 0x379c3800, 0x384c37c0, 0x384c384c, 0x37cc3796, 0x379d3802, 0x38aa37c1, 0x38aa38aa
    .long 0x37ce3798, 0x37a83804, 0x390837cc, 0x39083908, 0x37d0379a, 0x37a93806, 0x396637cd, 0x39663966
    .long 0x37d2379c, 0x37a23808, 0x39c437c6, 0x39c439c4, 0x37d4379e, 0x37a3380a, 0x3a2237c7, 0x3a223a22
    .long 0x37d637a0, 0x37ae380c, 0x379137d2, 0x37ac3791, 0x37d837a2, 0x37af380e, 0x37ef37d3, 0x380a37ef
    .long 0x37da37a4, 0x37a83810, 0x384d37cc, 0x3868384d, 0x37dc37a6, 0x37a93812, 0x38ab37cd, 0x38c638ab
    .long 0x37de37a8, 0x37b43814, 0x390937d8, 0x39243909, 0x37e037aa, 0x37b53816, 0x396737d9, 0x39823967
    .long 0x37e237ac, 0x37ae3818, 0x39c537d2, 0x39e039c5, 0x37e437ae, 0x37af381a, 0x3a2337d3, 0x3a3e3a23
    .long 0x37e637b0, 0x3796381c, 0x37923802, 0x37ae3798, 0x37e837b2, 0x3797381e, 0x37f03803, 0x380c37f6
    .long 0x37ea37b4, 0x37903820, 0x384e37fc, 0x386a3854, 0x37ec37b6, 0x37913834, 0x38ac37fd, 0x38c838b2
    .long 0x380037b8, 0x379c3836, 0x390a3808, 0x39263910, 0x380237cc, 0x379d3838, 0x39683809, 0x3984396e
    .long 0x380437ce, 0x3796383a, 0x39c63802, 0x39e239cc, 0x380637d0, 0x3797383c, 0x3a243803, 0x3a403a2a
    .long 0x380837d2, 0x37a2383e, 0x3793380e, 0x37b03799, 0x380a37d4, 0x37a33840, 0x37f1380f, 0x380e37f7
    .long 0x380c37d6, 0x379c3842, 0x384f3808, 0x386c3855, 0x380e37d8, 0x379d3844, 0x38ad3809, 0x38ca38b3
    .long 0x381037da, 0x37a83846, 0x390b3814, 0x39283911, 0x381237dc, 0x37a93848, 0x39693815, 0x3986396f
    .long 0x381437de, 0x37a2384a, 0x39c7380e, 0x39e439cd, 0x381637e0, 0x37a3384c, 0x3a25380f, 0x3a423a2b
    .long 0x381837e2, 0x37ba384e, 0x3794383e, 0x37b237a0, 0x381a37e4, 0x37bb3850, 0x37f2383f, 0x381037fe
    .long 0x381c37e6, 0x37b43852, 0x38503838, 0x386e385c, 0x381e37e8, 0x37b53854, 0x38ae3839, 0x38cc38ba
    .long 0x382037ea, 0x37c03856, 0x390c3844, 0x392a3918, 0x382237ec, 0x37c13858, 0x396a3845, 0x39883976
    .long 0x382437ee, 0x37ba385a, 0x39c8383e, 0x39e639d4, 0x382637f0, 0x37bb385c, 0x3a26383f, 0x3a443a32
    .long 0x382837f2, 0x37c63870, 0x3795384a, 0x37b437a1, 0x383c37f4, 0x37c73872, 0x37f3384b, 0x381237ff
    .long 0x383e3808, 0x37c03874, 0x38513844, 0x3870385d, 0x3840380a, 0x37c13876, 0x38af3845, 0x38ce38bb
    .long 0x3842380c, 0x37cc3878, 0x390d3850, 0x392c3919, 0x3844380e, 0x37cd387a, 0x396b3851, 0x398a3977
    .long 0x38463810, 0x37c6387c, 0x39c9384a, 0x39e839d5, 0x38483812, 0x37c7387e, 0x3a27384b, 0x3a463a33
    .long 0x384a3814, 0x37ae3880, 0x3796387a, 0x37b637a8, 0x384c3816, 0x37af3882, 0x37f4387b, 0x38143806
    .long 0x384e3818, 0x37a83884, 0x38523874, 0x38723864, 0x3850381a, 0x37a93886, 0x38b03875, 0x38d038c2
    .long 0x3852381c, 0x37b43888, 0x390e3880, 0x392e3920, 0x3854381e, 0x37b5388a, 0x396c3881, 0x398c397e
    .long 0x38563820, 0x37ae388c, 0x39ca387a, 0x39ea39dc, 0x38583822, 0x37af388e, 0x3a28387b, 0x3a483a3a
    .long 0x385a3824, 0x37ba3890, 0x37973886, 0x37b837a9, 0x385c3826, 0x37bb3892, 0x37f53887, 0x38163807
    .long 0x385e3828, 0x37b43894, 0x38533880, 0x38743865, 0x3860382a, 0x37b53896, 0x38b13881, 0x38d238c3
    .long 0x3862382c, 0x37c03898, 0x390f388c, 0x39303921, 0x3864382e, 0x37c138ac, 0x396d388d, 0x398e397f
    .long 0x38783830, 0x37ba38ae, 0x39cb3886, 0x39ec39dd, 0x387a3844, 0x37bb38b0, 0x3a293887, 0x3a4a3a3b
    .long 0x3ab63a80, 0x3a923aec, 0x3a803ab6, 0x3a803a80, 0x3ab83a82, 0x3a933aee, 0x3ade3ab7, 0x3ade3ade
    .long 0x3aba3a84, 0x3a8c3af0, 0x3b3c3ab0, 0x3b3c3b3c, 0x3abc3a86, 0x3a8d3af2, 0x3b9a3ab1, 0x3b9a3b9a
    .long 0x3abe3a88, 0x3a983af4, 0x3bf83abc, 0x3bf83bf8, 0x3ac03a8a, 0x3a993af6, 0x3c563abd, 0x3c563c56
    .long 0x3ac23a8c, 0x3a923af8, 0x3cb43ab6, 0x3cb43cb4, 0x3ac43a8e, 0x3a933afa, 0x3d123ab7, 0x3d123d12
    .long 0x3ac63a90, 0x3a9e3afc, 0x3a813ac2, 0x3a9c3a81, 0x3ac83a92, 0x3a9f3afe, 0x3adf3ac3, 0x3afa3adf
    .long 0x3aca3a94, 0x3a983b00, 0x3b3d3abc, 0x3b583b3d, 0x3acc3a96, 0x3a993b02, 0x3b9b3abd, 0x3bb63b9b
    .long 0x3ace3a98, 0x3aa43b04, 0x3bf93ac8, 0x3c143bf9, 0x3ad03a9a, 0x3aa53b06, 0x3c573ac9, 0x3c723c57
    .long 0x3ad23a9c, 0x3a9e3b08, 0x3cb53ac2, 0x3cd03cb5, 0x3ad43a9e, 0x3a9f3b0a, 0x3d133ac3, 0x3d2e3d13
    .long 0x3ad63aa0, 0x3a863b0c, 0x3a823af2, 0x3a9e3a88, 0x3ad83aa2, 0x3a873b0e, 0x3ae03af3, 0x3afc3ae6
    .long 0x3ada3aa4, 0x3a803b10, 0x3b3e3aec, 0x3b5a3b44, 0x3adc3aa6, 0x3a813b24, 0x3b9c3aed, 0x3bb83ba2
    .long 0x3af03aa8, 0x3a8c3b26, 0x3bfa3af8, 0x3c163c00, 0x3af23abc, 0x3a8d3b28, 0x3c583af9, 0x3c743c5e
    .long 0x3af43abe, 0x3a863b2a, 0x3cb63af2, 0x3cd23cbc, 0x3af63ac0, 0x3a873b2c, 0x3d143af3, 0x3d303d1a
    .long 0x3af83ac2, 0x3a923b2e, 0x3a833afe, 0x3aa03a89, 0x3afa3ac4, 0x3a933b30, 0x3ae13aff, 0x3afe3ae7
    .long 0x3afc3ac6, 0x3a8c3b32, 0x3b3f3af8, 0x3b5c3b45, 0x3afe3ac8, 0x3a8d3b34, 0x3b9d3af9, 0x3bba3ba3
    .long 0x3b003aca, 0x3a983b36, 0x3bfb3b04, 0x3c183c01, 0x3b023acc, 0x3a993b38, 0x3c593b05, 0x3c763c5f
    .long 0x3b043ace, 0x3a923b3a, 0x3cb73afe, 0x3cd43cbd, 0x3b063ad0, 0x3a933b3c, 0x3d153aff, 0x3d323d1b
    .long 0x3b083ad2, 0x3aaa3b3e, 0x3a843b2e, 0x3aa23a90, 0x3b0a3ad4, 0x3aab3b40, 0x3ae23b2f, 0x3b003aee
    .long 0x3b0c3ad6, 0x3aa43b42, 0x3b403b28, 0x3b5e3b4c, 0x3b0e3ad8, 0x3aa53b44, 0x3b9e3b29, 0x3bbc3baa
    .long 0x3b103ada, 0x3ab03b46, 0x3bfc3b34, 0x3c1a3c08, 0x3b123adc, 0x3ab13b48, 0x3c5a3b35, 0x3c783c66
    .long 0x3b143ade, 0x3aaa3b4a, 0x3cb83b2e, 0x3cd63cc4, 0x3b163ae0, 0x3aab3b4c, 0x3d163b2f, 0x3d343d22
    .long 0x3b183ae2, 0x3ab63b60, 0x3a853b3a, 0x3aa43a91, 0x3b2c3ae4, 0x3ab73b62, 0x3ae33b3b, 0x3b023aef
    .long 0x3b2e3af8, 0x3ab03b64, 0x3b413b34, 0x3b603b4d, 0x3b303afa, 0x3ab13b66, 0x3b9f3b35, 0x3bbe3bab
    .long 0x3b323afc, 0x3abc3b68, 0x3bfd3b40, 0x3c1c3c09, 0x3b343afe, 0x3abd3b6a, 0x3c5b3b41, 0x3c7a3c67
    .long 0x3b363b00, 0x3ab63b6c, 0x3cb93b3a, 0x3cd83cc5, 0x3b383b02, 0x3ab73b6e, 0x3d173b3b, 0x3d363d23
    .long 0x3b3a3b04, 0x3a9e3b70, 0x3a863b6a, 0x3aa63a98, 0x3b3c3b06, 0x3a9f3b72, 0x3ae43b6b, 0x3b043af6
    .long 0x3b3e3b08, 0x3a983b74, 0x3b423b64, 0x3b623b54, 0x3b403b0a, 0x3a993b76, 0x3ba03b65, 0x3bc03bb2
    .long 0x3b423b0c, 0x3aa43b78, 0x3bfe3b70, 0x3c1e3c10, 0x3b443b0e, 0x3aa53b7a, 0x3c5c3b71, 0x3c7c3c6e
    .long 0x3b463b10, 0x3a9e3b7c, 0x3cba3b6a, 0x3cda3ccc, 0x3b483b12, 0x3a9f3b7e, 0x3d183b6b, 0x3d383d2a
    .long 0x3b4a3b14, 0x3aaa3b80, 0x3a873b76, 0x3aa83a99, 0x3b4c3b16, 0x3aab3b82, 0x3ae53b77, 0x3b063af7
    .long 0x3b4e3b18, 0x3aa43b84, 0x3b433b70, 0x3b643b55, 0x3b503b1a, 0x3aa53b86, 0x3ba13b71, 0x3bc23bb3
    .long 0x3b523b1c, 0x3ab03b88, 0x3bff3b7c, 0x3c203c11, 0x3b543b1e, 0x3ab13b9c, 0x3c5d3b7d, 0x3c7e3c6f
    .long 0x3b683b20, 0x3aaa3b9e, 0x3cbb3b76, 0x3cdc3ccd, 0x3b6a3b34, 0x3aab3ba0, 0x3d193b77, 0x3d3a3d2b
    .long 0x31b431b0, 0x31bc31b8, 0x31d431d0, 0x31dc31d8, 0x31b531b1, 0x31bd31b9, 0x31d531d1, 0x31dd31d9
    .long 0x31b631b2, 0x31be31ba, 0x31d631d2, 0x31de31da, 0x31b731b3, 0x31bf31bb, 0x31d731d3, 0x31df31db
    .long 0x31b031ec, 0x31b831ec, 0x31d031ec, 0x31d831ec, 0x31b131ec, 0x31b931ec, 0x31d131ec, 0x31d931ec
    .long 0x31b231ec, 0x31ba31ec, 0x31d231ec, 0x31da31ec, 0x31b331ec, 0x31bb31ec, 0x31d331ec, 0x31db31ec
    .long 0x31ec31ec, 0x31b431b0, 0x31cc31c8, 0x31d431d0, 0x31ec31ec, 0x31b531b1, 0x31cd31c9, 0x31d531d1
    .long 0x31ec31ec, 0x31b631b2, 0x31ce31ca, 0x31d631d2, 0x31ec31ec, 0x31b731b3, 0x31cf31cb, 0x31d731d3
    .long 0x31ec31ec, 0x31b031ec, 0x31c831ec, 0x31d031ec, 0x31ec31ec, 0x31b131ec, 0x31c931ec, 0x31d131ec
    .long 0x31ec31ec, 0x31b231ec, 0x31ca31ec, 0x31d231ec, 0x31ec31ec, 0x31b331ec, 0x31cb31ec, 0x31d331ec
    .long 0x31c431c0, 0x31cc31c8, 0x31e431e0, 0x31ec31ec, 0x31c531c1, 0x31cd31c9, 0x31e531e1, 0x31ec31ec
    .long 0x31c631c2, 0x31ce31ca, 0x31e631e2, 0x31ec31ec, 0x31c731c3, 0x31cf31cb, 0x31e731e3, 0x31ec31ec
    .long 0x31c031ec, 0x31c831ec, 0x31e031ec, 0x31ec31ec, 0x31c131ec, 0x31c931ec, 0x31e131ec, 0x31ec31ec
    .long 0x31c231ec, 0x31ca31ec, 0x31e231ec, 0x31ec31ec, 0x31c331ec, 0x31cb31ec, 0x31e331ec, 0x31ec31ec
    .long 0x31bc31b8, 0x31c431c0, 0x31dc31d8, 0x31e431e0, 0x31bd31b9, 0x31c531c1, 0x31dd31d9, 0x31e531e1
    .long 0x31be31ba, 0x31c631c2, 0x31de31da, 0x31e631e2, 0x31bf31bb, 0x31c731c3, 0x31df31db, 0x31e731e3
    .long 0x31b831ec, 0x31c031ec, 0x31d831ec, 0x31e031ec, 0x31b931ec, 0x31c131ec, 0x31d931ec, 0x31e131ec
    .long 0x31ba31ec, 0x31c231ec, 0x31da31ec, 0x31e231ec, 0x31bb31ec, 0x31c331ec, 0x31db31ec, 0x31e331ec
    .long 0x320a320a, 0x320a320a, 0x32083208, 0x32083208, 0x320a320a, 0x320a320a, 0x32083208, 0x32083208
    .long 0x320a31e8, 0x320a31f0, 0x320831f2, 0x320831fa, 0x320a31e9, 0x320a31f1, 0x320831f3, 0x320831fb
    .long 0x320a31b4, 0x320a31bc, 0x320831d4, 0x320831dc, 0x320a31b5, 0x320a31bd, 0x320831d5, 0x320831dd
    .long 0x31e831b6, 0x31f031be, 0x31f231d6, 0x31fa31de, 0x31e931b7, 0x31f131bf, 0x31f331d7, 0x31fb31df
    .long 0x320a320a, 0x320a320a, 0x32083208, 0x32083208, 0x320a320a, 0x320a320a, 0x32083208, 0x32083208
    .long 0x320a320a, 0x320a31e8, 0x320831ea, 0x320831f2, 0x320a320a, 0x320a31e9, 0x320831eb, 0x320831f3
    .long 0x320a320a, 0x320a31b4, 0x320831cc, 0x320831d4, 0x320a320a, 0x320a31b5, 0x320831cd, 0x320831d5
    .long 0x320a320a, 0x31e831b6, 0x31ea31ce, 0x31f231d6, 0x320a320a, 0x31e931b7, 0x31eb31cf, 0x31f331d7
    .long 0x320a320a, 0x320a320a, 0x32083208, 0x32083208, 0x320a320a, 0x320a320a, 0x32083208, 0x32083208
    .long 0x320a31f8, 0x320a3200, 0x32083202, 0x32083208, 0x320a31f9, 0x320a3201, 0x32083203, 0x32083208
    .long 0x320a31c4, 0x320a31cc, 0x320831e4, 0x32083208, 0x320a31c5, 0x320a31cd, 0x320831e5, 0x32083208
    .long 0x31f831c6, 0x320031ce, 0x320231e6, 0x32083208, 0x31f931c7, 0x320131cf, 0x320331e7, 0x32083208
    .long 0x320a320a, 0x320a320a, 0x32083208, 0x32083208, 0x320a320a, 0x320a320a, 0x32083208, 0x32083208
    .long 0x320a31f0, 0x320a31f8, 0x320831fa, 0x32083202, 0x320a31f1, 0x320a31f9, 0x320831fb, 0x32083203
    .long 0x320a31bc, 0x320a31c4, 0x320831dc, 0x320831e4, 0x320a31bd, 0x320a31c5, 0x320831dd, 0x320831e5
    .long 0x31f031be, 0x31f831c6, 0x31fa31de, 0x320231e6, 0x31f131bf, 0x31f931c7, 0x31fb31df, 0x320331e7
    .long 0x34a434a0, 0x34ac34a8, 0x34c434c0, 0x34cc34c8, 0x34a534a1, 0x34ad34a9, 0x34c534c1, 0x34cd34c9
    .long 0x34a634a2, 0x34ae34aa, 0x34c634c2, 0x34ce34ca, 0x34a734a3, 0x34af34ab, 0x34c734c3, 0x34cf34cb
    .long 0x34a034dc, 0x34a834dc, 0x34c034dc, 0x34c834dc, 0x34a134dc, 0x34a934dc, 0x34c134dc, 0x34c934dc
    .long 0x34a234dc, 0x34aa34dc, 0x34c234dc, 0x34ca34dc, 0x34a334dc, 0x34ab34dc, 0x34c334dc, 0x34cb34dc
    .long 0x34dc34dc, 0x34a434a0, 0x34bc34b8, 0x34c434c0, 0x34dc34dc, 0x34a534a1, 0x34bd34b9, 0x34c534c1
    .long 0x34dc34dc, 0x34a634a2, 0x34be34ba, 0x34c634c2, 0x34dc34dc, 0x34a734a3, 0x34bf34bb, 0x34c734c3
    .long 0x34dc34dc, 0x34a034dc, 0x34b834dc, 0x34c034dc, 0x34dc34dc, 0x34a134dc, 0x34b934dc, 0x34c134dc
    .long 0x34dc34dc, 0x34a234dc, 0x34ba34dc, 0x34c234dc, 0x34dc34dc, 0x34a334dc, 0x34bb34dc, 0x34c334dc
    .long 0x34b434b0, 0x34bc34b8, 0x34d434d0, 0x34dc34dc, 0x34b534b1, 0x34bd34b9, 0x34d534d1, 0x34dc34dc
    .long 0x34b634b2, 0x34be34ba, 0x34d634d2, 0x34dc34dc, 0x34b734b3, 0x34bf34bb, 0x34d734d3, 0x34dc34dc
    .long 0x34b034dc, 0x34b834dc, 0x34d034dc, 0x34dc34dc, 0x34b134dc, 0x34b934dc, 0x34d134dc, 0x34dc34dc
    .long 0x34b234dc, 0x34ba34dc, 0x34d234dc, 0x34dc34dc, 0x34b334dc, 0x34bb34dc, 0x34d334dc, 0x34dc34dc
    .long 0x34ac34a8, 0x34b434b0, 0x34cc34c8, 0x34d434d0, 0x34ad34a9, 0x34b534b1, 0x34cd34c9, 0x34d534d1
    .long 0x34ae34aa, 0x34b634b2, 0x34ce34ca, 0x34d634d2, 0x34af34ab, 0x34b734b3, 0x34cf34cb, 0x34d734d3
    .long 0x34a834dc, 0x34b034dc, 0x34c834dc, 0x34d034dc, 0x34a934dc, 0x34b134dc, 0x34c934dc, 0x34d134dc
    .long 0x34aa34dc, 0x34b234dc, 0x34ca34dc, 0x34d234dc, 0x34ab34dc, 0x34b334dc, 0x34cb34dc, 0x34d334dc
    .long 0x34fa34fa, 0x34fa34fa, 0x34f834f8, 0x34f834f8, 0x34fa34fa, 0x34fa34fa, 0x34f834f8, 0x34f834f8
    .long 0x34fa34d8, 0x34fa34e0, 0x34f834e2, 0x34f834ea, 0x34fa34d9, 0x34fa34e1, 0x34f834e3, 0x34f834eb
    .long 0x34fa34a4, 0x34fa34ac, 0x34f834c4, 0x34f834cc, 0x34fa34a5, 0x34fa34ad, 0x34f834c5, 0x34f834cd
    .long 0x34d834a6, 0x34e034ae, 0x34e234c6, 0x34ea34ce, 0x34d934a7, 0x34e134af, 0x34e334c7, 0x34eb34cf
    .long 0x34fa34fa, 0x34fa34fa, 0x34f834f8, 0x34f834f8, 0x34fa34fa, 0x34fa34fa, 0x34f834f8, 0x34f834f8
    .long 0x34fa34fa, 0x34fa34d8, 0x34f834da, 0x34f834e2, 0x34fa34fa, 0x34fa34d9, 0x34f834db, 0x34f834e3
    .long 0x34fa34fa, 0x34fa34a4, 0x34f834bc, 0x34f834c4, 0x34fa34fa, 0x34fa34a5, 0x34f834bd, 0x34f834c5
    .long 0x34fa34fa, 0x34d834a6, 0x34da34be, 0x34e234c6, 0x34fa34fa, 0x34d934a7, 0x34db34bf, 0x34e334c7
    .long 0x34fa34fa, 0x34fa34fa, 0x34f834f8, 0x34f834f8, 0x34fa34fa, 0x34fa34fa, 0x34f834f8, 0x34f834f8
    .long 0x34fa34e8, 0x34fa34f0, 0x34f834f2, 0x34f834f8, 0x34fa34e9, 0x34fa34f1, 0x34f834f3, 0x34f834f8
    .long 0x34fa34b4, 0x34fa34bc, 0x34f834d4, 0x34f834f8, 0x34fa34b5, 0x34fa34bd, 0x34f834d5, 0x34f834f8
    .long 0x34e834b6, 0x34f034be, 0x34f234d6, 0x34f834f8, 0x34e934b7, 0x34f134bf, 0x34f334d7, 0x34f834f8
    .long 0x34fa34fa, 0x34fa34fa, 0x34f834f8, 0x34f834f8, 0x34fa34fa, 0x34fa34fa, 0x34f834f8, 0x34f834f8
    .long 0x34fa34e0, 0x34fa34e8, 0x34f834ea, 0x34f834f2, 0x34fa34e1, 0x34fa34e9, 0x34f834eb, 0x34f834f3
    .long 0x34fa34ac, 0x34fa34b4, 0x34f834cc, 0x34f834d4, 0x34fa34ad, 0x34fa34b5, 0x34f834cd, 0x34f834d5
    .long 0x34e034ae, 0x34e834b6, 0x34ea34ce, 0x34f234d6, 0x34e134af, 0x34e934b7, 0x34eb34cf, 0x34f334d7
    .long 0x37943790, 0x379c3798, 0x37b437b0, 0x37bc37b8, 0x37953791, 0x379d3799, 0x37b537b1, 0x37bd37b9
    .long 0x37963792, 0x379e379a, 0x37b637b2, 0x37be37ba, 0x37973793, 0x379f379b, 0x37b737b3, 0x37bf37bb
    .long 0x379037cc, 0x379837cc, 0x37b037cc, 0x37b837cc, 0x379137cc, 0x379937cc, 0x37b137cc, 0x37b937cc
    .long 0x379237cc, 0x379a37cc, 0x37b237cc, 0x37ba37cc, 0x379337cc, 0x379b37cc, 0x37b337cc, 0x37bb37cc
    .long 0x37cc37cc, 0x37943790, 0x37ac37a8, 0x37b437b0, 0x37cc37cc, 0x37953791, 0x37ad37a9, 0x37b537b1
    .long 0x37cc37cc, 0x37963792, 0x37ae37aa, 0x37b637b2, 0x37cc37cc, 0x37973793, 0x37af37ab, 0x37b737b3
    .long 0x37cc37cc, 0x379037cc, 0x37a837cc, 0x37b037cc, 0x37cc37cc, 0x379137cc, 0x37a937cc, 0x37b137cc
    .long 0x37cc37cc, 0x379237cc, 0x37aa37cc, 0x37b237cc, 0x37cc37cc, 0x379337cc, 0x37ab37cc, 0x37b337cc
    .long 0x37a437a0, 0x37ac37a8, 0x37c437c0, 0x37cc37cc, 0x37a537a1, 0x37ad37a9, 0x37c537c1, 0x37cc37cc
    .long 0x37a637a2, 0x37ae37aa, 0x37c637c2, 0x37cc37cc, 0x37a737a3, 0x37af37ab, 0x37c737c3, 0x37cc37cc
    .long 0x37a037cc, 0x37a837cc, 0x37c037cc, 0x37cc37cc, 0x37a137cc, 0x37a937cc, 0x37c137cc, 0x37cc37cc
    .long 0x37a237cc, 0x37aa37cc, 0x37c237cc, 0x37cc37cc, 0x37a337cc, 0x37ab37cc, 0x37c337cc, 0x37cc37cc
    .long 0x379c3798, 0x37a437a0, 0x37bc37b8, 0x37c437c0, 0x379d3799, 0x37a537a1, 0x37bd37b9, 0x37c537c1
    .long 0x379e379a, 0x37a637a2, 0x37be37ba, 0x37c637c2, 0x379f379b, 0x37a737a3, 0x37bf37bb, 0x37c737c3
    .long 0x379837cc, 0x37a037cc, 0x37b837cc, 0x37c037cc, 0x379937cc, 0x37a137cc, 0x37b937cc, 0x37c137cc
    .long 0x379a37cc, 0x37a237cc, 0x37ba37cc, 0x37c237cc, 0x379b37cc, 0x37a337cc, 0x37bb37cc, 0x37c337cc
    .long 0x37ea37ea, 0x37ea37ea, 0x37e837e8, 0x37e837e8, 0x37ea37ea, 0x37ea37ea, 0x37e837e8, 0x37e837e8
    .long 0x37ea37c8, 0x37ea37d0, 0x37e837d2, 0x37e837da, 0x37ea37c9, 0x37ea37d1, 0x37e837d3, 0x37e837db
    .long 0x37ea3794, 0x37ea379c, 0x37e837b4, 0x37e837bc, 0x37ea3795, 0x37ea379d, 0x37e837b5, 0x37e837bd
    .long 0x37c83796, 0x37d0379e, 0x37d237b6, 0x37da37be, 0x37c93797, 0x37d1379f, 0x37d337b7, 0x37db37bf
    .long 0x37ea37ea, 0x37ea37ea, 0x37e837e8, 0x37e837e8, 0x37ea37ea, 0x37ea37ea, 0x37e837e8, 0x37e837e8
    .long 0x37ea37ea, 0x37ea37c8, 0x37e837ca, 0x37e837d2, 0x37ea37ea, 0x37ea37c9, 0x37e837cb, 0x37e837d3
    .long 0x37ea37ea, 0x37ea3794, 0x37e837ac, 0x37e837b4, 0x37ea37ea, 0x37ea3795, 0x37e837ad, 0x37e837b5
    .long 0x37ea37ea, 0x37c83796, 0x37ca37ae, 0x37d237b6, 0x37ea37ea, 0x37c93797, 0x37cb37af, 0x37d337b7
    .long 0x37ea37ea, 0x37ea37ea, 0x37e837e8, 0x37e837e8, 0x37ea37ea, 0x37ea37ea, 0x37e837e8, 0x37e837e8
    .long 0x37ea37d8, 0x37ea37e0, 0x37e837e2, 0x37e837e8, 0x37ea37d9, 0x37ea37e1, 0x37e837e3, 0x37e837e8
    .long 0x37ea37a4, 0x37ea37ac, 0x37e837c4, 0x37e837e8, 0x37ea37a5, 0x37ea37ad, 0x37e837c5, 0x37e837e8
    .long 0x37d837a6, 0x37e037ae, 0x37e237c6, 0x37e837e8, 0x37d937a7, 0x37e137af, 0x37e337c7, 0x37e837e8
    .long 0x37ea37ea, 0x37ea37ea, 0x37e837e8, 0x37e837e8, 0x37ea37ea, 0x37ea37ea, 0x37e837e8, 0x37e837e8
    .long 0x37ea37d0, 0x37ea37d8, 0x37e837da, 0x37e837e2, 0x37ea37d1, 0x37ea37d9, 0x37e837db, 0x37e837e3
    .long 0x37ea379c, 0x37ea37a4, 0x37e837bc, 0x37e837c4, 0x37ea379d, 0x37ea37a5, 0x37e837bd, 0x37e837c5
    .long 0x37d0379e, 0x37d837a6, 0x37da37be, 0x37e237c6, 0x37d1379f, 0x37d937a7, 0x37db37bf, 0x37e337c7
    .long 0x3a843a80, 0x3a8c3a88, 0x3aa43aa0, 0x3aac3aa8, 0x3a853a81, 0x3a8d3a89, 0x3aa53aa1, 0x3aad3aa9
    .long 0x3a863a82, 0x3a8e3a8a, 0x3aa63aa2, 0x3aae3aaa, 0x3a873a83, 0x3a8f3a8b, 0x3aa73aa3, 0x3aaf3aab
    .long 0x3a803abc, 0x3a883abc, 0x3aa03abc, 0x3aa83abc, 0x3a813abc, 0x3a893abc, 0x3aa13abc, 0x3aa93abc
    .long 0x3a823abc, 0x3a8a3abc, 0x3aa23abc, 0x3aaa3abc, 0x3a833abc, 0x3a8b3abc, 0x3aa33abc, 0x3aab3abc
    .long 0x3abc3abc, 0x3a843a80, 0x3a9c3a98, 0x3aa43aa0, 0x3abc3abc, 0x3a853a81, 0x3a9d3a99, 0x3aa53aa1
    .long 0x3abc3abc, 0x3a863a82, 0x3a9e3a9a, 0x3aa63aa2, 0x3abc3abc, 0x3a873a83, 0x3a9f3a9b, 0x3aa73aa3
    .long 0x3abc3abc, 0x3a803abc, 0x3a983abc, 0x3aa03abc, 0x3abc3abc, 0x3a813abc, 0x3a993abc, 0x3aa13abc
    .long 0x3abc3abc, 0x3a823abc, 0x3a9a3abc, 0x3aa23abc, 0x3abc3abc, 0x3a833abc, 0x3a9b3abc, 0x3aa33abc
    .long 0x3a943a90, 0x3a9c3a98, 0x3ab43ab0, 0x3abc3abc, 0x3a953a91, 0x3a9d3a99, 0x3ab53ab1, 0x3abc3abc
    .long 0x3a963a92, 0x3a9e3a9a, 0x3ab63ab2, 0x3abc3abc, 0x3a973a93, 0x3a9f3a9b, 0x3ab73ab3, 0x3abc3abc
    .long 0x3a903abc, 0x3a983abc, 0x3ab03abc, 0x3abc3abc, 0x3a913abc, 0x3a993abc, 0x3ab13abc, 0x3abc3abc
    .long 0x3a923abc, 0x3a9a3abc, 0x3ab23abc, 0x3abc3abc, 0x3a933abc, 0x3a9b3abc, 0x3ab33abc, 0x3abc3abc
    .long 0x3a8c3a88, 0x3a943a90, 0x3aac3aa8, 0x3ab43ab0, 0x3a8d3a89, 0x3a953a91, 0x3aad3aa9, 0x3ab53ab1
    .long 0x3a8e3a8a, 0x3a963a92, 0x3aae3aaa, 0x3ab63ab2, 0x3a8f3a8b, 0x3a973a93, 0x3aaf3aab, 0x3ab73ab3
    .long 0x3a883abc, 0x3a903abc, 0x3aa83abc, 0x3ab03abc, 0x3a893abc, 0x3a913abc, 0x3aa93abc, 0x3ab13abc
    .long 0x3a8a3abc, 0x3a923abc, 0x3aaa3abc, 0x3ab23abc, 0x3a8b3abc, 0x3a933abc, 0x3aab3abc, 0x3ab33abc
    .long 0x3ada3ada, 0x3ada3ada, 0x3ad83ad8, 0x3ad83ad8, 0x3ada3ada, 0x3ada3ada, 0x3ad83ad8, 0x3ad83ad8
    .long 0x3ada3ab8, 0x3ada3ac0, 0x3ad83ac2, 0x3ad83aca, 0x3ada3ab9, 0x3ada3ac1, 0x3ad83ac3, 0x3ad83acb
    .long 0x3ada3a84, 0x3ada3a8c, 0x3ad83aa4, 0x3ad83aac, 0x3ada3a85, 0x3ada3a8d, 0x3ad83aa5, 0x3ad83aad
    .long 0x3ab83a86, 0x3ac03a8e, 0x3ac23aa6, 0x3aca3aae, 0x3ab93a87, 0x3ac13a8f, 0x3ac33aa7, 0x3acb3aaf
    .long 0x3ada3ada, 0x3ada3ada, 0x3ad83ad8, 0x3ad83ad8, 0x3ada3ada, 0x3ada3ada, 0x3ad83ad8, 0x3ad83ad8
    .long 0x3ada3ada, 0x3ada3ab8, 0x3ad83aba, 0x3ad83ac2, 0x3ada3ada, 0x3ada3ab9, 0x3ad83abb, 0x3ad83ac3
    .long 0x3ada3ada, 0x3ada3a84, 0x3ad83a9c, 0x3ad83aa4, 0x3ada3ada, 0x3ada3a85, 0x3ad83a9d, 0x3ad83aa5
    .long 0x3ada3ada, 0x3ab83a86, 0x3aba3a9e, 0x3ac23aa6, 0x3ada3ada, 0x3ab93a87, 0x3abb3a9f, 0x3ac33aa7
    .long 0x3ada3ada, 0x3ada3ada, 0x3ad83ad8, 0x3ad83ad8, 0x3ada3ada, 0x3ada3ada, 0x3ad83ad8, 0x3ad83ad8
    .long 0x3ada3ac8, 0x3ada3ad0, 0x3ad83ad2, 0x3ad83ad8, 0x3ada3ac9, 0x3ada3ad1, 0x3ad83ad3, 0x3ad83ad8
    .long 0x3ada3a94, 0x3ada3a9c, 0x3ad83ab4, 0x3ad83ad8, 0x3ada3a95, 0x3ada3a9d, 0x3ad83ab5, 0x3ad83ad8
    .long 0x3ac83a96, 0x3ad03a9e, 0x3ad23ab6, 0x3ad83ad8, 0x3ac93a97, 0x3ad13a9f, 0x3ad33ab7, 0x3ad83ad8
    .long 0x3ada3ada, 0x3ada3ada, 0x3ad83ad8, 0x3ad83ad8, 0x3ada3ada, 0x3ada3ada, 0x3ad83ad8, 0x3ad83ad8
    .long 0x3ada3ac0, 0x3ada3ac8, 0x3ad83aca, 0x3ad83ad2, 0x3ada3ac1, 0x3ada3ac9, 0x3ad83acb, 0x3ad83ad3
    .long 0x3ada3a8c, 0x3ada3a94, 0x3ad83aac, 0x3ad83ab4, 0x3ada3a8d, 0x3ada3a95, 0x3ad83aad, 0x3ad83ab5
    .long 0x3ac03a8e, 0x3ac83a96, 0x3aca3aae, 0x3ad23ab6, 0x3ac13a8f, 0x3ac93a97, 0x3acb3aaf, 0x3ad33ab7
    .long 0x4980000, 0x6040498, 0x8dc0770, 0x38000000, 0x49a0002, 0x61e04b2, 0x8f6078a, 0x38020002
    .long 0x4a40004, 0x63804cc, 0x91007a4, 0x38040004, 0x4a60006, 0x65204e6, 0x92a07be, 0x38060006
    .long 0x4b00060, 0x66c0500, 0x94407d8, 0x38080008, 0x4b20062, 0x686051a, 0x95e07f2, 0x380a000a
    .long 0x4bc0064, 0x6a00534, 0x978080c, 0x380c000c, 0x4be0066, 0x6ba054e, 0x9920826, 0x380e000e
    .long 0x4c800c0, 0x6d40568, 0x9ac0840, 0x38100010, 0x4ca00c2, 0x6ee0582, 0x9c6085a, 0x38120012
    .long 0x4d400c4, 0x708059c, 0x9e00874, 0x38140014, 0x4d600c6, 0x72205b6, 0x9fa088e, 0x38160016
    .long 0x4e00120, 0x73c05d0, 0xa1408a8, 0x38180018, 0x4e20122, 0x75605ea, 0xa2e08c2, 0x381a001a
    .long 0x4e00124, 0x18e818e8, 0x18e818e8, 0x381c001c, 0x4e20126, 0x18e818e8, 0x18e818e8, 0x381e001e
    .long 0x4a40180, 0xbb40a48, 0x165e15a8, 0x38200020, 0x4a60182, 0xbce0a62, 0x18e818e8, 0x38220022
    .long 0x4b00184, 0xbe80a7c, 0x167815c2, 0x38240024, 0x4b20186, 0xc020a96, 0x18e818e8, 0x38260026
    .long 0x4bc01e0, 0xc1c0ab0, 0x169215dc, 0x38280028, 0x4be01e2, 0xc360aca, 0x18e818e8, 0x382a002a
    .long 0x4c801e4, 0xc500ae4, 0x16ac15f6, 0x382c002c, 0x4ca01e6, 0xc6a0afe, 0x18e818e8, 0x382e002e
    .long 0x4d40240, 0xc840b18, 0x16c61610, 0x38300030, 0x4d60242, 0xc9e0b32, 0x18e818e8, 0x38320032
    .long 0x4e00244, 0xcb80b4c, 0x16e0162a, 0x38340034, 0x4e20246, 0xcd20b66, 0x18e818e8, 0x38360036
    .long 0x4ec02a0, 0xcec0b80, 0x16fa1644, 0x38380038, 0x4ee02a2, 0xd060b9a, 0x18e818e8, 0x383a003a
    .long 0x4ec02a4, 0x18e818e8, 0x18e818e8, 0x383c003c, 0x4ee02a6, 0x18e818e8, 0x18e818e8, 0x383e003e
    .long 0x49a0300, 0xe8c0d20, 0x11640ff8, 0x38400040, 0x49c0302, 0xea60d3a, 0x117e1012, 0x38420042
    .long 0x4a60304, 0xec00d54, 0x1198102c, 0x38440044, 0x4a80306, 0xeda0d6e, 0x11b21046, 0x38460046
    .long 0x4b20360, 0xef40d88, 0x11cc1060, 0x38480048, 0x4b40362, 0xf0e0da2, 0x11e6107a, 0x384a004a
    .long 0x4be0364, 0xf280dbc, 0x12001094, 0x384c004c, 0x4c00366, 0xf420dd6, 0x121a10ae, 0x384e004e
    .long 0x4ca03c0, 0xf5c0df0, 0x123410c8, 0x38500050, 0x4cc03c2, 0xf760e0a, 0x124e10e2, 0x38520052
    .long 0x4d603c4, 0xf900e24, 0x126810fc, 0x38540054, 0x4d803c6, 0xfaa0e3e, 0x12821116, 0x38560056
    .long 0x4e20420, 0xfc40e58, 0x129c1130, 0x38580058, 0x4e40422, 0xfde0e72, 0x12b6114a, 0x385a005a
    .long 0x4e20424, 0x18e818e8, 0x18e818e8, 0x385c005c, 0x4e40426, 0x18e818e8, 0x18e818e8, 0x385e005e
    .long 0x4a60480, 0x143c12d0, 0x17ca1714, 0x38600060, 0x4a80482, 0x145612ea, 0x18e818e8, 0x38620062
    .long 0x4b20484, 0x14701304, 0x17e4172e, 0x38640064, 0x4b40486, 0x148a131e, 0x18e818e8, 0x38660066
    .long 0x4be04e0, 0x14a41338, 0x17fe1748, 0x38680068, 0x4c004e2, 0x14be1352, 0x18e818e8, 0x386a006a
    .long 0x4ca04e4, 0x14d8136c, 0x18181762, 0x386c006c, 0x4cc04e6, 0x14f21386, 0x18e818e8, 0x386e006e
    .long 0x4d60540, 0x150c13a0, 0x1832177c, 0x38700070, 0x4d80542, 0x152613ba, 0x18e818e8, 0x38720072
    .long 0x4e20544, 0x154013d4, 0x184c1796, 0x38740074, 0x4e40546, 0x155a13ee, 0x18e818e8, 0x38760076
    .long 0x4ee05a0, 0x15741408, 0x186617b0, 0x38780078, 0x4f005a2, 0x158e1422, 0x18e818e8, 0x387a007a
    .long 0x4ee05a4, 0x18e818e8, 0x18e818e8, 0x387c007c, 0x4f005a6, 0x18e818e8, 0x18e818e8, 0x387e007e
    .long 0xfde0000, 0x60a049e, 0x8e20776, 0x3c800100, 0xfe00002, 0x62404b8, 0x8fc0790, 0x3c820102
    .long 0xfea0004, 0x63e04d2, 0x91607aa, 0x3c840104, 0xfec0006, 0x65804ec, 0x93007c4, 0x3c860106
    .long 0xff60060, 0x6720506, 0x94a07de, 0x3c880108, 0xff80062, 0x68c0520, 0x96407f8, 0x3c8a010a
    .long 0x10020064, 0x6a6053a, 0x97e0812, 0x3c8c010c, 0x10040066, 0x6c00554, 0x998082c, 0x3c8e010e
    .long 0x100e00c0, 0x6da056e, 0x9b20846, 0x3c900110, 0x101000c2, 0x6f40588, 0x9cc0860, 0x3c920112
    .long 0x101a00c4, 0x70e05a2, 0x9e6087a, 0x3c940114, 0x101c00c6, 0x72805bc, 0xa000894, 0x3c960116
    .long 0x10260120, 0x74205d6, 0xa1a08ae, 0x3c980118, 0x10280122, 0x75c05f0, 0xa3408c8, 0x3c9a011a
    .long 0x10260124, 0x18ee18ee, 0x18ee18ee, 0x3c9c011c, 0x10280126, 0x18ee18ee, 0x18ee18ee, 0x3c9e011e
    .long 0xfea0180, 0xbba0a4e, 0x166415ae, 0x3ca00120, 0xfec0182, 0xbd40a68, 0x18ee18ee, 0x3ca20122
    .long 0xff60184, 0xbee0a82, 0x167e15c8, 0x3ca40124, 0xff80186, 0xc080a9c, 0x18ee18ee, 0x3ca60126
    .long 0x100201e0, 0xc220ab6, 0x169815e2, 0x3ca80128, 0x100401e2, 0xc3c0ad0, 0x18ee18ee, 0x3caa012a
    .long 0x100e01e4, 0xc560aea, 0x16b215fc, 0x3cac012c, 0x101001e6, 0xc700b04, 0x18ee18ee, 0x3cae012e
    .long 0x101a0240, 0xc8a0b1e, 0x16cc1616, 0x3cb00130, 0x101c0242, 0xca40b38, 0x18ee18ee, 0x3cb20132
    .long 0x10260244, 0xcbe0b52, 0x16e61630, 0x3cb40134, 0x10280246, 0xcd80b6c, 0x18ee18ee, 0x3cb60136
    .long 0x103202a0, 0xcf20b86, 0x1700164a, 0x3cb80138, 0x103402a2, 0xd0c0ba0, 0x18ee18ee, 0x3cba013a
    .long 0x103202a4, 0x18ee18ee, 0x18ee18ee, 0x3cbc013c, 0x103402a6, 0x18ee18ee, 0x18ee18ee, 0x3cbe013e
    .long 0xfe00300, 0xe920d26, 0x116a0ffe, 0x3cc00140, 0xfe20302, 0xeac0d40, 0x11841018, 0x3cc20142
    .long 0xfec0304, 0xec60d5a, 0x119e1032, 0x3cc40144, 0xfee0306, 0xee00d74, 0x11b8104c, 0x3cc60146
    .long 0xff80360, 0xefa0d8e, 0x11d21066, 0x3cc80148, 0xffa0362, 0xf140da8, 0x11ec1080, 0x3cca014a
    .long 0x10040364, 0xf2e0dc2, 0x1206109a, 0x3ccc014c, 0x10060366, 0xf480ddc, 0x122010b4, 0x3cce014e
    .long 0x101003c0, 0xf620df6, 0x123a10ce, 0x3cd00150, 0x101203c2, 0xf7c0e10, 0x125410e8, 0x3cd20152
    .long 0x101c03c4, 0xf960e2a, 0x126e1102, 0x3cd40154, 0x101e03c6, 0xfb00e44, 0x1288111c, 0x3cd60156
    .long 0x10280420, 0xfca0e5e, 0x12a21136, 0x3cd80158, 0x102a0422, 0xfe40e78, 0x12bc1150, 0x3cda015a
    .long 0x10280424, 0x18ee18ee, 0x18ee18ee, 0x3cdc015c, 0x102a0426, 0x18ee18ee, 0x18ee18ee, 0x3cde015e
    .long 0xfec0480, 0x144212d6, 0x17d0171a, 0x3ce00160, 0xfee0482, 0x145c12f0, 0x18ee18ee, 0x3ce20162
    .long 0xff80484, 0x1476130a, 0x17ea1734, 0x3ce40164, 0xffa0486, 0x14901324, 0x18ee18ee, 0x3ce60166
    .long 0x100404e0, 0x14aa133e, 0x1804174e, 0x3ce80168, 0x100604e2, 0x14c41358, 0x18ee18ee, 0x3cea016a
    .long 0x101004e4, 0x14de1372, 0x181e1768, 0x3cec016c, 0x101204e6, 0x14f8138c, 0x18ee18ee, 0x3cee016e
    .long 0x101c0540, 0x151213a6, 0x18381782, 0x3cf00170, 0x101e0542, 0x152c13c0, 0x18ee18ee, 0x3cf20172
    .long 0x10280544, 0x154613da, 0x1852179c, 0x3cf40174, 0x102a0546, 0x156013f4, 0x18ee18ee, 0x3cf60176
    .long 0x103405a0, 0x157a140e, 0x186c17b6, 0x3cf80178, 0x103605a2, 0x15941428, 0x18ee18ee, 0x3cfa017a
    .long 0x103405a4, 0x18ee18ee, 0x18ee18ee, 0x3cfc017c, 0x103605a6, 0x18ee18ee, 0x18ee18ee, 0x3cfe017e
    .long 0x1b240000, 0x61004a4, 0x8e8077c, 0x41000200, 0x1b260002, 0x62a04be, 0x9020796, 0x41020202
    .long 0x1b300004, 0x64404d8, 0x91c07b0, 0x41040204, 0x1b320006, 0x65e04f2, 0x93607ca, 0x41060206
    .long 0x1b3c0018, 0x678050c, 0x95007e4, 0x41080208, 0x1b3e001a, 0x6920526, 0x96a07fe, 0x410a020a
    .long 0x1b48001c, 0x6ac0540, 0x9840818, 0x410c020c, 0x1b4a001e, 0x6c6055a, 0x99e0832, 0x410e020e
    .long 0x1b540030, 0x6e00574, 0x9b8084c, 0x41100210, 0x1b560032, 0x6fa058e, 0x9d20866, 0x41120212
    .long 0x1b600034, 0x71405a8, 0x9ec0880, 0x41140214, 0x1b620036, 0x72e05c2, 0xa06089a, 0x41160216
    .long 0x1b6c0048, 0x74805dc, 0xa2008b4, 0x41180218, 0x1b6e004a, 0x76205f6, 0xa3a08ce, 0x411a021a
    .long 0x1b6c004c, 0x18f418f4, 0x18f418f4, 0x411c021c, 0x1b6e004e, 0x18f418f4, 0x18f418f4, 0x411e021e
    .long 0x1b3000c0, 0xbc00a54, 0x166a15b4, 0x41200220, 0x1b3200c2, 0xbda0a6e, 0x18f418f4, 0x41220222
    .long 0x1b3c00c4, 0xbf40a88, 0x168415ce, 0x41240224, 0x1b3e00c6, 0xc0e0aa2, 0x18f418f4, 0x41260226
    .long 0x1b4800d8, 0xc280abc, 0x169e15e8, 0x41280228, 0x1b4a00da, 0xc420ad6, 0x18f418f4, 0x412a022a
    .long 0x1b5400dc, 0xc5c0af0, 0x16b81602, 0x412c022c, 0x1b5600de, 0xc760b0a, 0x18f418f4, 0x412e022e
    .long 0x1b6000f0, 0xc900b24, 0x16d2161c, 0x41300230, 0x1b6200f2, 0xcaa0b3e, 0x18f418f4, 0x41320232
    .long 0x1b6c00f4, 0xcc40b58, 0x16ec1636, 0x41340234, 0x1b6e00f6, 0xcde0b72, 0x18f418f4, 0x41360236
    .long 0x1b780108, 0xcf80b8c, 0x17061650, 0x41380238, 0x1b7a010a, 0xd120ba6, 0x18f418f4, 0x413a023a
    .long 0x1b78010c, 0x18f418f4, 0x18f418f4, 0x413c023c, 0x1b7a010e, 0x18f418f4, 0x18f418f4, 0x413e023e
    .long 0x1b260060, 0xe980d2c, 0x11701004, 0x41400240, 0x1b280062, 0xeb20d46, 0x118a101e, 0x41420242
    .long 0x1b320064, 0xecc0d60, 0x11a41038, 0x41440244, 0x1b340066, 0xee60d7a, 0x11be1052, 0x41460246
    .long 0x1b3e0078, 0xf000d94, 0x11d8106c, 0x41480248, 0x1b40007a, 0xf1a0dae, 0x11f21086, 0x414a024a
    .long 0x1b4a007c, 0xf340dc8, 0x120c10a0, 0x414c024c, 0x1b4c007e, 0xf4e0de2, 0x122610ba, 0x414e024e
    .long 0x1b560090, 0xf680dfc, 0x124010d4, 0x41500250, 0x1b580092, 0xf820e16, 0x125a10ee, 0x41520252
    .long 0x1b620094, 0xf9c0e30, 0x12741108, 0x41540254, 0x1b640096, 0xfb60e4a, 0x128e1122, 0x41560256
    .long 0x1b6e00a8, 0xfd00e64, 0x12a8113c, 0x41580258, 0x1b7000aa, 0xfea0e7e, 0x12c21156, 0x415a025a
    .long 0x1b6e00ac, 0x18f418f4, 0x18f418f4, 0x415c025c, 0x1b7000ae, 0x18f418f4, 0x18f418f4, 0x415e025e
    .long 0x1b320120, 0x144812dc, 0x17d61720, 0x41600260, 0x1b340122, 0x146212f6, 0x18f418f4, 0x41620262
    .long 0x1b3e0124, 0x147c1310, 0x17f0173a, 0x41640264, 0x1b400126, 0x1496132a, 0x18f418f4, 0x41660266
    .long 0x1b4a0138, 0x14b01344, 0x180a1754, 0x41680268, 0x1b4c013a, 0x14ca135e, 0x18f418f4, 0x416a026a
    .long 0x1b56013c, 0x14e41378, 0x1824176e, 0x416c026c, 0x1b58013e, 0x14fe1392, 0x18f418f4, 0x416e026e
    .long 0x1b620150, 0x151813ac, 0x183e1788, 0x41700270, 0x1b640152, 0x153213c6, 0x18f418f4, 0x41720272
    .long 0x1b6e0154, 0x154c13e0, 0x185817a2, 0x41740274, 0x1b700156, 0x156613fa, 0x18f418f4, 0x41760276
    .long 0x1b7a0168, 0x15801414, 0x187217bc, 0x41780278, 0x1b7c016a, 0x159a142e, 0x18f418f4, 0x417a027a
    .long 0x1b7a016c, 0x18f418f4, 0x18f418f4, 0x417c027c, 0x1b7c016e, 0x18f418f4, 0x18f418f4, 0x417e027e
    .long 0x266a0000, 0x61604aa, 0x8ee0782, 0x45800300, 0x266c0002, 0x63004c4, 0x908079c, 0x45820302
    .long 0x26760004, 0x64a04de, 0x92207b6, 0x45840304, 0x26780006, 0x66404f8, 0x93c07d0, 0x45860306
    .long 0x26820018, 0x67e0512, 0x95607ea, 0x45880308, 0x2684001a, 0x698052c, 0x9700804, 0x458a030a
    .long 0x268e001c, 0x6b20546, 0x98a081e, 0x458c030c, 0x2690001e, 0x6cc0560, 0x9a40838, 0x458e030e
    .long 0x269a0030, 0x6e6057a, 0x9be0852, 0x45900310, 0x269c0032, 0x7000594, 0x9d8086c, 0x45920312
    .long 0x26a60034, 0x71a05ae, 0x9f20886, 0x45940314, 0x26a80036, 0x73405c8, 0xa0c08a0, 0x45960316
    .long 0x26b20048, 0x74e05e2, 0xa2608ba, 0x45980318, 0x26b4004a, 0x76805fc, 0xa4008d4, 0x459a031a
    .long 0x26b2004c, 0x18fa18fa, 0x18fa18fa, 0x459c031c, 0x26b4004e, 0x18fa18fa, 0x18fa18fa, 0x459e031e
    .long 0x267600c0, 0xbc60a5a, 0x167015ba, 0x45a00320, 0x267800c2, 0xbe00a74, 0x18fa18fa, 0x45a20322
    .long 0x268200c4, 0xbfa0a8e, 0x168a15d4, 0x45a40324, 0x268400c6, 0xc140aa8, 0x18fa18fa, 0x45a60326
    .long 0x268e00d8, 0xc2e0ac2, 0x16a415ee, 0x45a80328, 0x269000da, 0xc480adc, 0x18fa18fa, 0x45aa032a
    .long 0x269a00dc, 0xc620af6, 0x16be1608, 0x45ac032c, 0x269c00de, 0xc7c0b10, 0x18fa18fa, 0x45ae032e
    .long 0x26a600f0, 0xc960b2a, 0x16d81622, 0x45b00330, 0x26a800f2, 0xcb00b44, 0x18fa18fa, 0x45b20332
    .long 0x26b200f4, 0xcca0b5e, 0x16f2163c, 0x45b40334, 0x26b400f6, 0xce40b78, 0x18fa18fa, 0x45b60336
    .long 0x26be0108, 0xcfe0b92, 0x170c1656, 0x45b80338, 0x26c0010a, 0xd180bac, 0x18fa18fa, 0x45ba033a
    .long 0x26be010c, 0x18fa18fa, 0x18fa18fa, 0x45bc033c, 0x26c0010e, 0x18fa18fa, 0x18fa18fa, 0x45be033e
    .long 0x266c0060, 0xe9e0d32, 0x1176100a, 0x45c00340, 0x266e0062, 0xeb80d4c, 0x11901024, 0x45c20342
    .long 0x26780064, 0xed20d66, 0x11aa103e, 0x45c40344, 0x267a0066, 0xeec0d80, 0x11c41058, 0x45c60346
    .long 0x26840078, 0xf060d9a, 0x11de1072, 0x45c80348, 0x2686007a, 0xf200db4, 0x11f8108c, 0x45ca034a
    .long 0x2690007c, 0xf3a0dce, 0x121210a6, 0x45cc034c, 0x2692007e, 0xf540de8, 0x122c10c0, 0x45ce034e
    .long 0x269c0090, 0xf6e0e02, 0x124610da, 0x45d00350, 0x269e0092, 0xf880e1c, 0x126010f4, 0x45d20352
    .long 0x26a80094, 0xfa20e36, 0x127a110e, 0x45d40354, 0x26aa0096, 0xfbc0e50, 0x12941128, 0x45d60356
    .long 0x26b400a8, 0xfd60e6a, 0x12ae1142, 0x45d80358, 0x26b600aa, 0xff00e84, 0x12c8115c, 0x45da035a
    .long 0x26b400ac, 0x18fa18fa, 0x18fa18fa, 0x45dc035c, 0x26b600ae, 0x18fa18fa, 0x18fa18fa, 0x45de035e
    .long 0x26780120, 0x144e12e2, 0x17dc1726, 0x45e00360, 0x267a0122, 0x146812fc, 0x18fa18fa, 0x45e20362
    .long 0x26840124, 0x14821316, 0x17f61740, 0x45e40364, 0x26860126, 0x149c1330, 0x18fa18fa, 0x45e60366
    .long 0x26900138, 0x14b6134a, 0x1810175a, 0x45e80368, 0x2692013a, 0x14d01364, 0x18fa18fa, 0x45ea036a
    .long 0x269c013c, 0x14ea137e, 0x182a1774, 0x45ec036c, 0x269e013e, 0x15041398, 0x18fa18fa, 0x45ee036e
    .long 0x26a80150, 0x151e13b2, 0x1844178e, 0x45f00370, 0x26aa0152, 0x153813cc, 0x18fa18fa, 0x45f20372
    .long 0x26b40154, 0x155213e6, 0x185e17a8, 0x45f40374, 0x26b60156, 0x156c1400, 0x18fa18fa, 0x45f60376
    .long 0x26c00168, 0x1586141a, 0x187817c2, 0x45f80378, 0x26c2016a, 0x15a01434, 0x18fa18fa, 0x45fa037a
    .long 0x26c0016c, 0x18fa18fa, 0x18fa18fa, 0x45fc037c, 0x26c2016e, 0x18fa18fa, 0x18fa18fa, 0x45fe037e
    .long 0x11980498, 0x4001818, 0x400, 0x1fa4, 0x11b204b2, 0x4041832, 0x600404, 0x2a002004
    .long 0x11cc04cc, 0x408184c, 0x15000408, 0x540034a4, 0x11e604e6, 0x40c1866, 0x1560040c, 0x7e003504
    .long 0x12000500, 0x4800480, 0x2a000410, 0x449a4, 0x121a051a, 0x4800480, 0x2a600414, 0x2a044a04
    .long 0x12340534, 0x4800480, 0x3f000418, 0x54045ea4, 0x124e054e, 0x4800480, 0x3f60041c, 0x7e045f04
    .long 0x12680568, 0x4001818, 0x54000400, 0x73a4, 0x12820582, 0x4041832, 0x54600404, 0x7404
    .long 0x129c059c, 0x408184c, 0x69000408, 0x88a4, 0x12b605b6, 0x40c1866, 0x6960040c, 0x8904
    .long 0x12d005d0, 0x4800480, 0x7e000410, 0xab0, 0x12ea05ea, 0x4800480, 0x7e600414, 0xb10
    .long 0x13040604, 0x4800480, 0xc0418, 0x1fb0, 0x131e061e, 0x4800480, 0x6c041c, 0x2010
    .long 0x13380638, 0x4800480, 0x150c0402, 0x134b0, 0x13520652, 0x4800480, 0x156c0406, 0x2a013510
    .long 0x136c066c, 0x4800480, 0x2a0c040a, 0x540149b0, 0x13860686, 0x4800480, 0x2a6c040e, 0x7e014a10
    .long 0x13a006a0, 0x4001818, 0x3f0c0412, 0x55eb0, 0x13ba06ba, 0x4041832, 0x3f6c0416, 0x2a055f10
    .long 0x13d406d4, 0x408184c, 0x540c041a, 0x540573b0, 0x13ee06ee, 0x40c1866, 0x546c041e, 0x7e057410
    .long 0x14080708, 0x4800480, 0x690c0402, 0x88b0, 0x14220722, 0x4800480, 0x696c0406, 0x8910
    .long 0x143c073c, 0x4800480, 0x7e0c040a, 0xabc, 0x14560756, 0x4800480, 0x7e6c040e, 0xb1c
    .long 0x14700770, 0x4001818, 0x180412, 0x1fbc, 0x148a078a, 0x4041832, 0x780416, 0x201c
    .long 0x14a407a4, 0x408184c, 0x1518041a, 0x34bc, 0x14be07be, 0x40c1866, 0x1578041e, 0x351c
    .long 0x119a049a, 0x402181a, 0x10401, 0x21fa5, 0x11b404b4, 0x4061834, 0x610405, 0x2a022005
    .long 0x11ce04ce, 0x40a184e, 0x15010409, 0x540234a5, 0x11e804e8, 0x40e1868, 0x1561040d, 0x7e023505
    .long 0x12020502, 0x4800480, 0x2a010411, 0x649a5, 0x121c051c, 0x4800480, 0x2a610415, 0x2a064a05
    .long 0x12360536, 0x4800480, 0x3f010419, 0x54065ea5, 0x12500550, 0x4800480, 0x3f61041d, 0x7e065f05
    .long 0x126a056a, 0x402181a, 0x54010401, 0x73a5, 0x12840584, 0x4061834, 0x54610405, 0x7405
    .long 0x129e059e, 0x40a184e, 0x69010409, 0x88a5, 0x12b805b8, 0x40e1868, 0x6961040d, 0x8905
    .long 0x12d205d2, 0x4800480, 0x7e010411, 0xab1, 0x12ec05ec, 0x4800480, 0x7e610415, 0xb11
    .long 0x13060606, 0x4800480, 0xd0419, 0x1fb1, 0x13200620, 0x4800480, 0x6d041d, 0x2011
    .long 0x133a063a, 0x4800480, 0x150d0403, 0x334b1, 0x13540654, 0x4800480, 0x156d0407, 0x2a033511
    .long 0x136e066e, 0x4800480, 0x2a0d040b, 0x540349b1, 0x13880688, 0x4800480, 0x2a6d040f, 0x7e034a11
    .long 0x13a206a2, 0x402181a, 0x3f0d0413, 0x75eb1, 0x13bc06bc, 0x4061834, 0x3f6d0417, 0x2a075f11
    .long 0x13d606d6, 0x40a184e, 0x540d041b, 0x540773b1, 0x13f006f0, 0x40e1868, 0x546d041f, 0x7e077411
    .long 0x140a070a, 0x4800480, 0x690d0403, 0x88b1, 0x14240724, 0x4800480, 0x696d0407, 0x8911
    .long 0x143e073e, 0x4800480, 0x7e0d040b, 0xabd, 0x14580758, 0x4800480, 0x7e6d040f, 0xb1d
    .long 0x14720772, 0x402181a, 0x190413, 0x1fbd, 0x148c078c, 0x4061834, 0x790417, 0x201d
    .long 0x14a607a6, 0x40a184e, 0x1519041b, 0x34bd, 0x14c007c0, 0x40e1868, 0x1579041f, 0x351d
    .long 0x119807d8, 0x4201818, 0x2a180420, 0x1fa4, 0x11b207f2, 0x4241832, 0x2a780424, 0x2a002004
    .long 0x11cc080c, 0x428184c, 0x3f180428, 0x540034a4, 0x11e60826, 0x42c1866, 0x3f78042c, 0x7e003504
    .long 0x12000840, 0x4800480, 0x54180430, 0x449a4, 0x121a085a, 0x4800480, 0x54780434, 0x2a044a04
    .long 0x12340874, 0x4800480, 0x69180438, 0x54045ea4, 0x124e088e, 0x4800480, 0x6978043c, 0x7e045f04
    .long 0x126808a8, 0x4201818, 0x7e180420, 0x73a4, 0x128208c2, 0x4241832, 0x7e780424, 0x7404
    .long 0x129c08dc, 0x428184c, 0x240428, 0x88a4, 0x12b608f6, 0x42c1866, 0x84042c, 0x8904
    .long 0x12d00910, 0x4800480, 0x15240430, 0xab0, 0x12ea092a, 0x4800480, 0x15840434, 0xb10
    .long 0x13040944, 0x4800480, 0x2a240438, 0x1fb0, 0x131e095e, 0x4800480, 0x2a84043c, 0x2010
    .long 0x13380978, 0x4800480, 0x3f240422, 0x134b0, 0x13520992, 0x4800480, 0x3f840426, 0x2a013510
    .long 0x136c09ac, 0x4800480, 0x5424042a, 0x540149b0, 0x138609c6, 0x4800480, 0x5484042e, 0x7e014a10
    .long 0x13a009e0, 0x4201818, 0x69240432, 0x55eb0, 0x13ba09fa, 0x4241832, 0x69840436, 0x2a055f10
    .long 0x13d40a14, 0x428184c, 0x7e24043a, 0x540573b0, 0x13ee0a2e, 0x42c1866, 0x7e84043e, 0x7e057410
    .long 0x14080a48, 0x4800480, 0x300422, 0x88b0, 0x14220a62, 0x4800480, 0x900426, 0x8910
    .long 0x143c0a7c, 0x4800480, 0x1530042a, 0xabc, 0x14560a96, 0x4800480, 0x1590042e, 0xb1c
    .long 0x14700ab0, 0x4201818, 0x2a300432, 0x1fbc, 0x148a0aca, 0x4241832, 0x2a900436, 0x201c
    .long 0x14a40ae4, 0x428184c, 0x3f30043a, 0x34bc, 0x14be0afe, 0x42c1866, 0x3f90043e, 0x351c
    .long 0x119a07da, 0x422181a, 0x2a190421, 0x21fa5, 0x11b407f4, 0x4261834, 0x2a790425, 0x2a022005
    .long 0x11ce080e, 0x42a184e, 0x3f190429, 0x540234a5, 0x11e80828, 0x42e1868, 0x3f79042d, 0x7e023505
    .long 0x12020842, 0x4800480, 0x54190431, 0x649a5, 0x121c085c, 0x4800480, 0x54790435, 0x2a064a05
    .long 0x12360876, 0x4800480, 0x69190439, 0x54065ea5, 0x12500890, 0x4800480, 0x6979043d, 0x7e065f05
    .long 0x126a08aa, 0x422181a, 0x7e190421, 0x73a5, 0x128408c4, 0x4261834, 0x7e790425, 0x7405
    .long 0x129e08de, 0x42a184e, 0x250429, 0x88a5, 0x12b808f8, 0x42e1868, 0x85042d, 0x8905
    .long 0x12d20912, 0x4800480, 0x15250431, 0xab1, 0x12ec092c, 0x4800480, 0x15850435, 0xb11
    .long 0x13060946, 0x4800480, 0x2a250439, 0x1fb1, 0x13200960, 0x4800480, 0x2a85043d, 0x2011
    .long 0x133a097a, 0x4800480, 0x3f250423, 0x334b1, 0x13540994, 0x4800480, 0x3f850427, 0x2a033511
    .long 0x136e09ae, 0x4800480, 0x5425042b, 0x540349b1, 0x138809c8, 0x4800480, 0x5485042f, 0x7e034a11
    .long 0x13a209e2, 0x422181a, 0x69250433, 0x75eb1, 0x13bc09fc, 0x4261834, 0x69850437, 0x2a075f11
    .long 0x13d60a16, 0x42a184e, 0x7e25043b, 0x540773b1, 0x13f00a30, 0x42e1868, 0x7e85043f, 0x7e077411
    .long 0x140a0a4a, 0x4800480, 0x310423, 0x88b1, 0x14240a64, 0x4800480, 0x910427, 0x8911
    .long 0x143e0a7e, 0x4800480, 0x1531042b, 0xabd, 0x14580a98, 0x4800480, 0x1591042f, 0xb1d
    .long 0x14720ab2, 0x422181a, 0x2a310433, 0x1fbd, 0x148c0acc, 0x4261834, 0x2a910437, 0x201d
    .long 0x14a60ae6, 0x42a184e, 0x3f31043b, 0x34bd, 0x14c00b00, 0x42e1868, 0x3f91043f, 0x351d
    .long 0x14d80b18, 0x4401818, 0x54300440, 0x49bc, 0x14f20b32, 0x4441832, 0x54900444, 0x2a004a1c
    .long 0x150c0b4c, 0x448184c, 0x69300448, 0x54005ebc, 0x15260b66, 0x44c1866, 0x6990044c, 0x7e005f1c
    .long 0x15400b80, 0x4800480, 0x7e300450, 0x473bc, 0x155a0b9a, 0x4800480, 0x7e900454, 0x2a04741c
    .long 0x15740bb4, 0x4800480, 0x3c0458, 0x540488bc, 0x158e0bce, 0x4800480, 0x9c045c, 0x7e04891c
    .long 0x15a80be8, 0x4401818, 0x153c0440, 0x48, 0x15c20c02, 0x4441832, 0x159c0444, 0x1548
    .long 0x15dc0c1c, 0x448184c, 0x2a3c0448, 0x2a48, 0x15f60c36, 0x44c1866, 0x2a9c044c, 0x3f48
    .long 0x16100c50, 0x4800480, 0x3f3c0450, 0x5448, 0x162a0c6a, 0x4800480, 0x3f9c0454, 0x6948
    .long 0x16440c84, 0x4800480, 0x543c0458, 0x7e48, 0x165e0c9e, 0x4800480, 0x549c045c, 0x54
    .long 0x16780cb8, 0x4800480, 0x693c0442, 0x11554, 0x16920cd2, 0x4800480, 0x699c0446, 0x2a012a54
    .long 0x16ac0cec, 0x4800480, 0x7e3c044a, 0x54013f54, 0x16c60d06, 0x4800480, 0x7e9c044e, 0x7e015454
    .long 0x16e00d20, 0x4401818, 0xa800452, 0x56954, 0x16fa0d3a, 0x4441832, 0xae00456, 0x2a057e54
    .long 0x17140d54, 0x448184c, 0x1f80045a, 0x54050ac8, 0x172e0d6e, 0x44c1866, 0x1fe0045e, 0x7e051fc8
    .long 0x17480d88, 0x4800480, 0x34800442, 0x34c8, 0x17620da2, 0x4800480, 0x34e00446, 0x49c8
    .long 0x177c0dbc, 0x4800480, 0x4980044a, 0x5ec8, 0x17960dd6, 0x4800480, 0x49e0044e, 0x73c8
    .long 0x17b00df0, 0x4401818, 0x5e800452, 0x88c8, 0x17ca0e0a, 0x4441832, 0x5ee00456, 0xad4
    .long 0x17e40e24, 0x448184c, 0x7380045a, 0x1fd4, 0x17fe0e3e, 0x44c1866, 0x73e0045e, 0x34d4
    .long 0x14da0b1a, 0x442181a, 0x54310441, 0x249bd, 0x14f40b34, 0x4461834, 0x54910445, 0x2a024a1d
    .long 0x150e0b4e, 0x44a184e, 0x69310449, 0x54025ebd, 0x15280b68, 0x44e1868, 0x6991044d, 0x7e025f1d
    .long 0x15420b82, 0x4800480, 0x7e310451, 0x673bd, 0x155c0b9c, 0x4800480, 0x7e910455, 0x2a06741d
    .long 0x15760bb6, 0x4800480, 0x3d0459, 0x540688bd, 0x15900bd0, 0x4800480, 0x9d045d, 0x7e06891d
    .long 0x15aa0bea, 0x442181a, 0x153d0441, 0x49, 0x15c40c04, 0x4461834, 0x159d0445, 0x1549
    .long 0x15de0c1e, 0x44a184e, 0x2a3d0449, 0x2a49, 0x15f80c38, 0x44e1868, 0x2a9d044d, 0x3f49
    .long 0x16120c52, 0x4800480, 0x3f3d0451, 0x5449, 0x162c0c6c, 0x4800480, 0x3f9d0455, 0x6949
    .long 0x16460c86, 0x4800480, 0x543d0459, 0x7e49, 0x16600ca0, 0x4800480, 0x549d045d, 0x55
    .long 0x167a0cba, 0x4800480, 0x693d0443, 0x31555, 0x16940cd4, 0x4800480, 0x699d0447, 0x2a032a55
    .long 0x16ae0cee, 0x4800480, 0x7e3d044b, 0x54033f55, 0x16c80d08, 0x4800480, 0x7e9d044f, 0x7e035455
    .long 0x16e20d22, 0x442181a, 0xa810453, 0x76955, 0x16fc0d3c, 0x4461834, 0xae10457, 0x2a077e55
    .long 0x17160d56, 0x44a184e, 0x1f81045b, 0x54070ac9, 0x17300d70, 0x44e1868, 0x1fe1045f, 0x7e071fc9
    .long 0x174a0d8a, 0x4800480, 0x34810443, 0x34c9, 0x17640da4, 0x4800480, 0x34e10447, 0x49c9
    .long 0x177e0dbe, 0x4800480, 0x4981044b, 0x5ec9, 0x17980dd8, 0x4800480, 0x49e1044f, 0x73c9
    .long 0x17b20df2, 0x442181a, 0x5e810453, 0x88c9, 0x17cc0e0c, 0x4461834, 0x5ee10457, 0xad5
    .long 0x17e60e26, 0x44a184e, 0x7381045b, 0x1fd5, 0x18000e40, 0x44e1868, 0x73e1045f, 0x34d5
    .long 0x14d80e58, 0x4601818, 0x88800460, 0x49bc, 0x14f20e72, 0x4641832, 0x88e00464, 0x2a004a1c
    .long 0x150c0e8c, 0x468184c, 0xa8c0468, 0x54005ebc, 0x15260ea6, 0x46c1866, 0xaec046c, 0x7e005f1c
    .long 0x15400ec0, 0x4800480, 0x1f8c0470, 0x473bc, 0x155a0eda, 0x4800480, 0x1fec0474, 0x2a04741c
    .long 0x15740ef4, 0x4800480, 0x348c0478, 0x540488bc, 0x158e0f0e, 0x4800480, 0x34ec047c, 0x7e04891c
    .long 0x15a80f28, 0x4601818, 0x498c0460, 0x48, 0x15c20f42, 0x4641832, 0x49ec0464, 0x1548
    .long 0x15dc0f5c, 0x468184c, 0x5e8c0468, 0x2a48, 0x15f60f76, 0x46c1866, 0x5eec046c, 0x3f48
    .long 0x16100f90, 0x4800480, 0x738c0470, 0x5448, 0x162a0faa, 0x4800480, 0x73ec0474, 0x6948
    .long 0x16440fc4, 0x4800480, 0x888c0478, 0x7e48, 0x165e0fde, 0x4800480, 0x88ec047c, 0x54
    .long 0x16780ff8, 0x4800480, 0xa980462, 0x11554, 0x16921012, 0x4800480, 0xaf80466, 0x2a012a54
    .long 0x16ac102c, 0x4800480, 0x1f98046a, 0x54013f54, 0x16c61046, 0x4800480, 0x1ff8046e, 0x7e015454
    .long 0x16e01060, 0x4601818, 0x34980472, 0x56954, 0x16fa107a, 0x4641832, 0x34f80476, 0x2a057e54
    .long 0x17141094, 0x468184c, 0x4998047a, 0x54050ac8, 0x172e10ae, 0x46c1866, 0x49f8047e, 0x7e051fc8
    .long 0x174810c8, 0x4800480, 0x5e980462, 0x34c8, 0x176210e2, 0x4800480, 0x5ef80466, 0x49c8
    .long 0x177c10fc, 0x4800480, 0x7398046a, 0x5ec8, 0x17961116, 0x4800480, 0x73f8046e, 0x73c8
    .long 0x17b01130, 0x4601818, 0x88980472, 0x88c8, 0x17ca114a, 0x4641832, 0x88f80476, 0xad4
    .long 0x17e41164, 0x468184c, 0xaa4047a, 0x1fd4, 0x17fe117e, 0x46c1866, 0xb04047e, 0x34d4
    .long 0x14da0e5a, 0x462181a, 0x88810461, 0x249bd, 0x14f40e74, 0x4661834, 0x88e10465, 0x2a024a1d
    .long 0x150e0e8e, 0x46a184e, 0xa8d0469, 0x54025ebd, 0x15280ea8, 0x46e1868, 0xaed046d, 0x7e025f1d
    .long 0x15420ec2, 0x4800480, 0x1f8d0471, 0x673bd, 0x155c0edc, 0x4800480, 0x1fed0475, 0x2a06741d
    .long 0x15760ef6, 0x4800480, 0x348d0479, 0x540688bd, 0x15900f10, 0x4800480, 0x34ed047d, 0x7e06891d
    .long 0x15aa0f2a, 0x462181a, 0x498d0461, 0x49, 0x15c40f44, 0x4661834, 0x49ed0465, 0x1549
    .long 0x15de0f5e, 0x46a184e, 0x5e8d0469, 0x2a49, 0x15f80f78, 0x46e1868, 0x5eed046d, 0x3f49
    .long 0x16120f92, 0x4800480, 0x738d0471, 0x5449, 0x162c0fac, 0x4800480, 0x73ed0475, 0x6949
    .long 0x16460fc6, 0x4800480, 0x888d0479, 0x7e49, 0x16600fe0, 0x4800480, 0x88ed047d, 0x55
    .long 0x167a0ffa, 0x4800480, 0xa990463, 0x31555, 0x16941014, 0x4800480, 0xaf90467, 0x2a032a55
    .long 0x16ae102e, 0x4800480, 0x1f99046b, 0x54033f55, 0x16c81048, 0x4800480, 0x1ff9046f, 0x7e035455
    .long 0x16e21062, 0x462181a, 0x34990473, 0x76955, 0x16fc107c, 0x4661834, 0x34f90477, 0x2a077e55
    .long 0x17161096, 0x46a184e, 0x4999047b, 0x54070ac9, 0x173010b0, 0x46e1868, 0x49f9047f, 0x7e071fc9
    .long 0x174a10ca, 0x4800480, 0x5e990463, 0x34c9, 0x176410e4, 0x4800480, 0x5ef90467, 0x49c9
    .long 0x177e10fe, 0x4800480, 0x7399046b, 0x5ec9, 0x17981118, 0x4800480, 0x73f9046f, 0x73c9
    .long 0x17b21132, 0x462181a, 0x88990473, 0x88c9, 0x17cc114c, 0x4661834, 0x88f90477, 0xad5
    .long 0x17e61166, 0x46a184e, 0xaa5047b, 0x1fd5, 0x18001180, 0x46e1868, 0xb05047f, 0x34d5
    .long 0x2c003200, 0x20002600, 0x14001a00, 0x8000e00, 0x2c013201, 0x20012601, 0x14011a01, 0x8010e01
    .long 0x2c023202, 0x20022602, 0x14021a02, 0x8020e02, 0x2c033203, 0x20032603, 0x14031a03, 0x8030e03
    .long 0x2c083208, 0x20082608, 0x14081a08, 0x8080e08, 0x2c093209, 0x20092609, 0x14091a09, 0x8090e09
    .long 0x2c0a320a, 0x200a260a, 0x140a1a0a, 0x80a0e0a, 0x2c0b320b, 0x200b260b, 0x140b1a0b, 0x80b0e0b
    .long 0x2c103210, 0x20102610, 0x14101a10, 0x8100e10, 0x2c113211, 0x20112611, 0x14111a11, 0x8110e11
    .long 0x2c123212, 0x20122612, 0x14121a12, 0x8120e12, 0x2c133213, 0x20132613, 0x14131a13, 0x8130e13
    .long 0x2c183218, 0x20182618, 0x14181a18, 0x8180e18, 0x2c193219, 0x20192619, 0x14191a19, 0x8190e19
    .long 0x2c1a321a, 0x201a261a, 0x141a1a1a, 0x81a0e1a, 0x2c1b321b, 0x201b261b, 0x141b1a1b, 0x81b0e1b
    .long 0x2c043204, 0x20042604, 0x14041a04, 0x8040e04, 0x2c053205, 0x20052605, 0x14051a05, 0x8050e05
    .long 0x2c063206, 0x20062606, 0x14061a06, 0x8060e06, 0x2c073207, 0x20072607, 0x14071a07, 0x8070e07
    .long 0x2c0c320c, 0x200c260c, 0x140c1a0c, 0x80c0e0c, 0x2c0d320d, 0x200d260d, 0x140d1a0d, 0x80d0e0d
    .long 0x2c0e320e, 0x200e260e, 0x140e1a0e, 0x80e0e0e, 0x2c0f320f, 0x200f260f, 0x140f1a0f, 0x80f0e0f
    .long 0x2c143214, 0x20142614, 0x14141a14, 0x8140e14, 0x2c153215, 0x20152615, 0x14151a15, 0x8150e15
    .long 0x2c163216, 0x20162616, 0x14161a16, 0x8160e16, 0x2c173217, 0x20172617, 0x14171a17, 0x8170e17
    .long 0x2c1c321c, 0x201c261c, 0x141c1a1c, 0x81c0e1c, 0x2c1d321d, 0x201d261d, 0x141d1a1d, 0x81d0e1d
    .long 0x2c1e321e, 0x201e261e, 0x141e1a1e, 0x81e0e1e, 0x2c1f321f, 0x201f261f, 0x141f1a1f, 0x81f0e1f
    .long 0x2c403240, 0x20402640, 0x14401a40, 0x8400e40, 0x2c413241, 0x20412641, 0x14411a41, 0x8410e41
    .long 0x2c423242, 0x20422642, 0x14421a42, 0x8420e42, 0x2c433243, 0x20432643, 0x14431a43, 0x8430e43
    .long 0x2c483248, 0x20482648, 0x14481a48, 0x8480e48, 0x2c493249, 0x20492649, 0x14491a49, 0x8490e49
    .long 0x2c4a324a, 0x204a264a, 0x144a1a4a, 0x84a0e4a, 0x2c4b324b, 0x204b264b, 0x144b1a4b, 0x84b0e4b
    .long 0x2c503250, 0x20502650, 0x14501a50, 0x8500e50, 0x2c513251, 0x20512651, 0x14511a51, 0x8510e51
    .long 0x2c523252, 0x20522652, 0x14521a52, 0x8520e52, 0x2c533253, 0x20532653, 0x14531a53, 0x8530e53
    .long 0x2c583258, 0x20582658, 0x14581a58, 0x8580e58, 0x2c593259, 0x20592659, 0x14591a59, 0x8590e59
    .long 0x2c5a325a, 0x205a265a, 0x145a1a5a, 0x85a0e5a, 0x2c5b325b, 0x205b265b, 0x145b1a5b, 0x85b0e5b
    .long 0x2c443244, 0x20442644, 0x14441a44, 0x8440e44, 0x2c453245, 0x20452645, 0x14451a45, 0x8450e45
    .long 0x2c463246, 0x20462646, 0x14461a46, 0x8460e46, 0x2c473247, 0x20472647, 0x14471a47, 0x8470e47
    .long 0x2c4c324c, 0x204c264c, 0x144c1a4c, 0x84c0e4c, 0x2c4d324d, 0x204d264d, 0x144d1a4d, 0x84d0e4d
    .long 0x2c4e324e, 0x204e264e, 0x144e1a4e, 0x84e0e4e, 0x2c4f324f, 0x204f264f, 0x144f1a4f, 0x84f0e4f
    .long 0x2c543254, 0x20542654, 0x14541a54, 0x8540e54, 0x2c553255, 0x20552655, 0x14551a55, 0x8550e55
    .long 0x2c563256, 0x20562656, 0x14561a56, 0x8560e56, 0x2c573257, 0x20572657, 0x14571a57, 0x8570e57
    .long 0x2c5c325c, 0x205c265c, 0x145c1a5c, 0x85c0e5c, 0x2c5d325d, 0x205d265d, 0x145d1a5d, 0x85d0e5d
    .long 0x2c5e325e, 0x205e265e, 0x145e1a5e, 0x85e0e5e, 0x2c5f325f, 0x205f265f, 0x145f1a5f, 0x85f0e5f
    .long 0x32002c00, 0x26002000, 0x1a001400, 0xe000800, 0x32012c01, 0x26012001, 0x1a011401, 0xe010801
    .long 0x32022c02, 0x26022002, 0x1a021402, 0xe020802, 0x32032c03, 0x26032003, 0x1a031403, 0xe030803
    .long 0x32082c08, 0x26082008, 0x1a081408, 0xe080808, 0x32092c09, 0x26092009, 0x1a091409, 0xe090809
    .long 0x320a2c0a, 0x260a200a, 0x1a0a140a, 0xe0a080a, 0x320b2c0b, 0x260b200b, 0x1a0b140b, 0xe0b080b
    .long 0x32102c10, 0x26102010, 0x1a101410, 0xe100810, 0x32112c11, 0x26112011, 0x1a111411, 0xe110811
    .long 0x32122c12, 0x26122012, 0x1a121412, 0xe120812, 0x32132c13, 0x26132013, 0x1a131413, 0xe130813
    .long 0x32182c18, 0x26182018, 0x1a181418, 0xe180818, 0x32192c19, 0x26192019, 0x1a191419, 0xe190819
    .long 0x321a2c1a, 0x261a201a, 0x1a1a141a, 0xe1a081a, 0x321b2c1b, 0x261b201b, 0x1a1b141b, 0xe1b081b
    .long 0x32042c04, 0x26042004, 0x1a041404, 0xe040804, 0x32052c05, 0x26052005, 0x1a051405, 0xe050805
    .long 0x32062c06, 0x26062006, 0x1a061406, 0xe060806, 0x32072c07, 0x26072007, 0x1a071407, 0xe070807
    .long 0x320c2c0c, 0x260c200c, 0x1a0c140c, 0xe0c080c, 0x320d2c0d, 0x260d200d, 0x1a0d140d, 0xe0d080d
    .long 0x320e2c0e, 0x260e200e, 0x1a0e140e, 0xe0e080e, 0x320f2c0f, 0x260f200f, 0x1a0f140f, 0xe0f080f
    .long 0x32142c14, 0x26142014, 0x1a141414, 0xe140814, 0x32152c15, 0x26152015, 0x1a151415, 0xe150815
    .long 0x32162c16, 0x26162016, 0x1a161416, 0xe160816, 0x32172c17, 0x26172017, 0x1a171417, 0xe170817
    .long 0x321c2c1c, 0x261c201c, 0x1a1c141c, 0xe1c081c, 0x321d2c1d, 0x261d201d, 0x1a1d141d, 0xe1d081d
    .long 0x321e2c1e, 0x261e201e, 0x1a1e141e, 0xe1e081e, 0x321f2c1f, 0x261f201f, 0x1a1f141f, 0xe1f081f
    .long 0x32402c40, 0x26402040, 0x1a401440, 0xe400840, 0x32412c41, 0x26412041, 0x1a411441, 0xe410841
    .long 0x32422c42, 0x26422042, 0x1a421442, 0xe420842, 0x32432c43, 0x26432043, 0x1a431443, 0xe430843
    .long 0x32482c48, 0x26482048, 0x1a481448, 0xe480848, 0x32492c49, 0x26492049, 0x1a491449, 0xe490849
    .long 0x324a2c4a, 0x264a204a, 0x1a4a144a, 0xe4a084a, 0x324b2c4b, 0x264b204b, 0x1a4b144b, 0xe4b084b
    .long 0x32502c50, 0x26502050, 0x1a501450, 0xe500850, 0x32512c51, 0x26512051, 0x1a511451, 0xe510851
    .long 0x32522c52, 0x26522052, 0x1a521452, 0xe520852, 0x32532c53, 0x26532053, 0x1a531453, 0xe530853
    .long 0x32582c58, 0x26582058, 0x1a581458, 0xe580858, 0x32592c59, 0x26592059, 0x1a591459, 0xe590859
    .long 0x325a2c5a, 0x265a205a, 0x1a5a145a, 0xe5a085a, 0x325b2c5b, 0x265b205b, 0x1a5b145b, 0xe5b085b
    .long 0x32442c44, 0x26442044, 0x1a441444, 0xe440844, 0x32452c45, 0x26452045, 0x1a451445, 0xe450845
    .long 0x32462c46, 0x26462046, 0x1a461446, 0xe460846, 0x32472c47, 0x26472047, 0x1a471447, 0xe470847
    .long 0x324c2c4c, 0x264c204c, 0x1a4c144c, 0xe4c084c, 0x324d2c4d, 0x264d204d, 0x1a4d144d, 0xe4d084d
    .long 0x324e2c4e, 0x264e204e, 0x1a4e144e, 0xe4e084e, 0x324f2c4f, 0x264f204f, 0x1a4f144f, 0xe4f084f
    .long 0x32542c54, 0x26542054, 0x1a541454, 0xe540854, 0x32552c55, 0x26552055, 0x1a551455, 0xe550855
    .long 0x32562c56, 0x26562056, 0x1a561456, 0xe560856, 0x32572c57, 0x26572057, 0x1a571457, 0xe570857
    .long 0x325c2c5c, 0x265c205c, 0x1a5c145c, 0xe5c085c, 0x325d2c5d, 0x265d205d, 0x1a5d145d, 0xe5d085d
    .long 0x325e2c5e, 0x265e205e, 0x1a5e145e, 0xe5e085e, 0x325f2c5f, 0x265f205f, 0x1a5f145f, 0xe5f085f
    .long 0x20002600, 0x2c003200, 0x8000e00, 0x14001a00, 0x20012601, 0x2c013201, 0x8010e01, 0x14011a01
    .long 0x20022602, 0x2c023202, 0x8020e02, 0x14021a02, 0x20032603, 0x2c033203, 0x8030e03, 0x14031a03
    .long 0x20082608, 0x2c083208, 0x8080e08, 0x14081a08, 0x20092609, 0x2c093209, 0x8090e09, 0x14091a09
    .long 0x200a260a, 0x2c0a320a, 0x80a0e0a, 0x140a1a0a, 0x200b260b, 0x2c0b320b, 0x80b0e0b, 0x140b1a0b
    .long 0x20102610, 0x2c103210, 0x8100e10, 0x14101a10, 0x20112611, 0x2c113211, 0x8110e11, 0x14111a11
    .long 0x20122612, 0x2c123212, 0x8120e12, 0x14121a12, 0x20132613, 0x2c133213, 0x8130e13, 0x14131a13
    .long 0x20182618, 0x2c183218, 0x8180e18, 0x14181a18, 0x20192619, 0x2c193219, 0x8190e19, 0x14191a19
    .long 0x201a261a, 0x2c1a321a, 0x81a0e1a, 0x141a1a1a, 0x201b261b, 0x2c1b321b, 0x81b0e1b, 0x141b1a1b
    .long 0x20042604, 0x2c043204, 0x8040e04, 0x14041a04, 0x20052605, 0x2c053205, 0x8050e05, 0x14051a05
    .long 0x20062606, 0x2c063206, 0x8060e06, 0x14061a06, 0x20072607, 0x2c073207, 0x8070e07, 0x14071a07
    .long 0x200c260c, 0x2c0c320c, 0x80c0e0c, 0x140c1a0c, 0x200d260d, 0x2c0d320d, 0x80d0e0d, 0x140d1a0d
    .long 0x200e260e, 0x2c0e320e, 0x80e0e0e, 0x140e1a0e, 0x200f260f, 0x2c0f320f, 0x80f0e0f, 0x140f1a0f
    .long 0x20142614, 0x2c143214, 0x8140e14, 0x14141a14, 0x20152615, 0x2c153215, 0x8150e15, 0x14151a15
    .long 0x20162616, 0x2c163216, 0x8160e16, 0x14161a16, 0x20172617, 0x2c173217, 0x8170e17, 0x14171a17
    .long 0x201c261c, 0x2c1c321c, 0x81c0e1c, 0x141c1a1c, 0x201d261d, 0x2c1d321d, 0x81d0e1d, 0x141d1a1d
    .long 0x201e261e, 0x2c1e321e, 0x81e0e1e, 0x141e1a1e, 0x201f261f, 0x2c1f321f, 0x81f0e1f, 0x141f1a1f
    .long 0x20402640, 0x2c403240, 0x8400e40, 0x14401a40, 0x20412641, 0x2c413241, 0x8410e41, 0x14411a41
    .long 0x20422642, 0x2c423242, 0x8420e42, 0x14421a42, 0x20432643, 0x2c433243, 0x8430e43, 0x14431a43
    .long 0x20482648, 0x2c483248, 0x8480e48, 0x14481a48, 0x20492649, 0x2c493249, 0x8490e49, 0x14491a49
    .long 0x204a264a, 0x2c4a324a, 0x84a0e4a, 0x144a1a4a, 0x204b264b, 0x2c4b324b, 0x84b0e4b, 0x144b1a4b
    .long 0x20502650, 0x2c503250, 0x8500e50, 0x14501a50, 0x20512651, 0x2c513251, 0x8510e51, 0x14511a51
    .long 0x20522652, 0x2c523252, 0x8520e52, 0x14521a52, 0x20532653, 0x2c533253, 0x8530e53, 0x14531a53
    .long 0x20582658, 0x2c583258, 0x8580e58, 0x14581a58, 0x20592659, 0x2c593259, 0x8590e59, 0x14591a59
    .long 0x205a265a, 0x2c5a325a, 0x85a0e5a, 0x145a1a5a, 0x205b265b, 0x2c5b325b, 0x85b0e5b, 0x145b1a5b
    .long 0x20442644, 0x2c443244, 0x8440e44, 0x14441a44, 0x20452645, 0x2c453245, 0x8450e45, 0x14451a45
    .long 0x20462646, 0x2c463246, 0x8460e46, 0x14461a46, 0x20472647, 0x2c473247, 0x8470e47, 0x14471a47
    .long 0x204c264c, 0x2c4c324c, 0x84c0e4c, 0x144c1a4c, 0x204d264d, 0x2c4d324d, 0x84d0e4d, 0x144d1a4d
    .long 0x204e264e, 0x2c4e324e, 0x84e0e4e, 0x144e1a4e, 0x204f264f, 0x2c4f324f, 0x84f0e4f, 0x144f1a4f
    .long 0x20542654, 0x2c543254, 0x8540e54, 0x14541a54, 0x20552655, 0x2c553255, 0x8550e55, 0x14551a55
    .long 0x20562656, 0x2c563256, 0x8560e56, 0x14561a56, 0x20572657, 0x2c573257, 0x8570e57, 0x14571a57
    .long 0x205c265c, 0x2c5c325c, 0x85c0e5c, 0x145c1a5c, 0x205d265d, 0x2c5d325d, 0x85d0e5d, 0x145d1a5d
    .long 0x205e265e, 0x2c5e325e, 0x85e0e5e, 0x145e1a5e, 0x205f265f, 0x2c5f325f, 0x85f0e5f, 0x145f1a5f
    .long 0x26002000, 0x32002c00, 0xe000800, 0x1a001400, 0x26012001, 0x32012c01, 0xe010801, 0x1a011401
    .long 0x26022002, 0x32022c02, 0xe020802, 0x1a021402, 0x26032003, 0x32032c03, 0xe030803, 0x1a031403
    .long 0x26082008, 0x32082c08, 0xe080808, 0x1a081408, 0x26092009, 0x32092c09, 0xe090809, 0x1a091409
    .long 0x260a200a, 0x320a2c0a, 0xe0a080a, 0x1a0a140a, 0x260b200b, 0x320b2c0b, 0xe0b080b, 0x1a0b140b
    .long 0x26102010, 0x32102c10, 0xe100810, 0x1a101410, 0x26112011, 0x32112c11, 0xe110811, 0x1a111411
    .long 0x26122012, 0x32122c12, 0xe120812, 0x1a121412, 0x26132013, 0x32132c13, 0xe130813, 0x1a131413
    .long 0x26182018, 0x32182c18, 0xe180818, 0x1a181418, 0x26192019, 0x32192c19, 0xe190819, 0x1a191419
    .long 0x261a201a, 0x321a2c1a, 0xe1a081a, 0x1a1a141a, 0x261b201b, 0x321b2c1b, 0xe1b081b, 0x1a1b141b
    .long 0x26042004, 0x32042c04, 0xe040804, 0x1a041404, 0x26052005, 0x32052c05, 0xe050805, 0x1a051405
    .long 0x26062006, 0x32062c06, 0xe060806, 0x1a061406, 0x26072007, 0x32072c07, 0xe070807, 0x1a071407
    .long 0x260c200c, 0x320c2c0c, 0xe0c080c, 0x1a0c140c, 0x260d200d, 0x320d2c0d, 0xe0d080d, 0x1a0d140d
    .long 0x260e200e, 0x320e2c0e, 0xe0e080e, 0x1a0e140e, 0x260f200f, 0x320f2c0f, 0xe0f080f, 0x1a0f140f
    .long 0x26142014, 0x32142c14, 0xe140814, 0x1a141414, 0x26152015, 0x32152c15, 0xe150815, 0x1a151415
    .long 0x26162016, 0x32162c16, 0xe160816, 0x1a161416, 0x26172017, 0x32172c17, 0xe170817, 0x1a171417
    .long 0x261c201c, 0x321c2c1c, 0xe1c081c, 0x1a1c141c, 0x261d201d, 0x321d2c1d, 0xe1d081d, 0x1a1d141d
    .long 0x261e201e, 0x321e2c1e, 0xe1e081e, 0x1a1e141e, 0x261f201f, 0x321f2c1f, 0xe1f081f, 0x1a1f141f
    .long 0x26402040, 0x32402c40, 0xe400840, 0x1a401440, 0x26412041, 0x32412c41, 0xe410841, 0x1a411441
    .long 0x26422042, 0x32422c42, 0xe420842, 0x1a421442, 0x26432043, 0x32432c43, 0xe430843, 0x1a431443
    .long 0x26482048, 0x32482c48, 0xe480848, 0x1a481448, 0x26492049, 0x32492c49, 0xe490849, 0x1a491449
    .long 0x264a204a, 0x324a2c4a, 0xe4a084a, 0x1a4a144a, 0x264b204b, 0x324b2c4b, 0xe4b084b, 0x1a4b144b
    .long 0x26502050, 0x32502c50, 0xe500850, 0x1a501450, 0x26512051, 0x32512c51, 0xe510851, 0x1a511451
    .long 0x26522052, 0x32522c52, 0xe520852, 0x1a521452, 0x26532053, 0x32532c53, 0xe530853, 0x1a531453
    .long 0x26582058, 0x32582c58, 0xe580858, 0x1a581458, 0x26592059, 0x32592c59, 0xe590859, 0x1a591459
    .long 0x265a205a, 0x325a2c5a, 0xe5a085a, 0x1a5a145a, 0x265b205b, 0x325b2c5b, 0xe5b085b, 0x1a5b145b
    .long 0x26442044, 0x32442c44, 0xe440844, 0x1a441444, 0x26452045, 0x32452c45, 0xe450845, 0x1a451445
    .long 0x26462046, 0x32462c46, 0xe460846, 0x1a461446, 0x26472047, 0x32472c47, 0xe470847, 0x1a471447
    .long 0x264c204c, 0x324c2c4c, 0xe4c084c, 0x1a4c144c, 0x264d204d, 0x324d2c4d, 0xe4d084d, 0x1a4d144d
    .long 0x264e204e, 0x324e2c4e, 0xe4e084e, 0x1a4e144e, 0x264f204f, 0x324f2c4f, 0xe4f084f, 0x1a4f144f
    .long 0x26542054, 0x32542c54, 0xe540854, 0x1a541454, 0x26552055, 0x32552c55, 0xe550855, 0x1a551455
    .long 0x26562056, 0x32562c56, 0xe560856, 0x1a561456, 0x26572057, 0x32572c57, 0xe570857, 0x1a571457
    .long 0x265c205c, 0x325c2c5c, 0xe5c085c, 0x1a5c145c, 0x265d205d, 0x325d2c5d, 0xe5d085d, 0x1a5d145d
    .long 0x265e205e, 0x325e2c5e, 0xe5e085e, 0x1a5e145e, 0x265f205f, 0x325f2c5f, 0xe5f085f, 0x1a5f145f
    .long 0x600000, 0x20041fa4, 0x3b003c80, 0x49d0498, 0x610001, 0x20051fa5, 0x3b023c82, 0x85f085a
    .long 0x15601500, 0x350434a4, 0x3b043c84, 0xc210c1c, 0x15611501, 0x350534a5, 0x3b063c86, 0xfe30fde
    .long 0x2a602a00, 0x4a0449a4, 0x3b083c88, 0x13a513a0, 0x2a612a01, 0x4a0549a5, 0x3b0a3c8a, 0x17671762
    .long 0x3f603f00, 0x5f045ea4, 0x3b0c3c8c, 0x1b291b24, 0x3f613f01, 0x5f055ea5, 0x3b0e3c8e, 0x1eeb1ee6
    .long 0x54605400, 0x740473a4, 0x3b103c90, 0x22ad22a8, 0x54615401, 0x740573a5, 0x3b123c92, 0x266f266a
    .long 0x69606900, 0x890488a4, 0x3b143c94, 0x2a312a2c, 0x69616901, 0x890588a5, 0x3b163c96, 0x2df32dee
    .long 0x7e607e00, 0xb100ab0, 0x3b183c98, 0x5150499, 0x7e617e01, 0xb110ab1, 0x3b1a3c9a, 0x8d7085b
    .long 0x6c000c, 0x20101fb0, 0x3b1c3c9c, 0xc990c1d, 0x6d000d, 0x20111fb1, 0x3b1e3c9e, 0x105b0fdf
    .long 0x156c150c, 0x351034b0, 0x3b203ca0, 0x141d13a1, 0x156d150d, 0x351134b1, 0x3b223ca2, 0x17df1763
    .long 0x2a6c2a0c, 0x4a1049b0, 0x3b243ca4, 0x1ba11b25, 0x2a6d2a0d, 0x4a1149b1, 0x3b263ca6, 0x1f631ee7
    .long 0x3f6c3f0c, 0x5f105eb0, 0x3b283ca8, 0x232522a9, 0x3f6d3f0d, 0x5f115eb1, 0x3b2a3caa, 0x26e7266b
    .long 0x546c540c, 0x741073b0, 0x3b2c3cac, 0x2aa92a2d, 0x546d540d, 0x741173b1, 0x3b2e3cae, 0x2e6b2def
    .long 0x696c690c, 0x891088b0, 0x3b303cb0, 0x58d049a, 0x696d690d, 0x891188b1, 0x3b323cb2, 0x94f085c
    .long 0x7e6c7e0c, 0xb1c0abc, 0x3b343cb4, 0xd110c1e, 0x7e6d7e0d, 0xb1d0abd, 0x3b363cb6, 0x10d30fe0
    .long 0x780018, 0x201c1fbc, 0x3b383cb8, 0x149513a2, 0x790019, 0x201d1fbd, 0x3b3a3cba, 0x18571764
    .long 0x15781518, 0x351c34bc, 0x3b3c3cbc, 0x1c191b26, 0x15791519, 0x351d34bd, 0x3b3e3cbe, 0x1fdb1ee8
    .long 0x620002, 0x20061fa6, 0x3b403cc0, 0x239d22aa, 0x630003, 0x20071fa7, 0x3b423cc2, 0x275f266c
    .long 0x15621502, 0x350634a6, 0x3b443cc4, 0x2b212a2e, 0x15631503, 0x350734a7, 0x3b463cc6, 0x2ee32df0
    .long 0x2a622a02, 0x4a0649a6, 0x3b483cc8, 0x605049b, 0x2a632a03, 0x4a0749a7, 0x3b4a3cca, 0x9c7085d
    .long 0x3f623f02, 0x5f065ea6, 0x3b4c3ccc, 0xd890c1f, 0x3f633f03, 0x5f075ea7, 0x3b4e3cce, 0x114b0fe1
    .long 0x54625402, 0x740673a6, 0x3b503cd0, 0x150d13a3, 0x54635403, 0x740773a7, 0x3b523cd2, 0x18cf1765
    .long 0x69626902, 0x890688a6, 0x3b543cd4, 0x1c911b27, 0x69636903, 0x890788a7, 0x3b563cd6, 0x20531ee9
    .long 0x7e627e02, 0xb120ab2, 0x3b583cd8, 0x241522ab, 0x7e637e03, 0xb130ab3, 0x3b5a3cda, 0x27d7266d
    .long 0x6e000e, 0x20121fb2, 0x3b5c3cdc, 0x2b992a2f, 0x6f000f, 0x20131fb3, 0x3b5e3cde, 0x2f5b2df1
    .long 0x156e150e, 0x351234b2, 0x3b603ce0, 0x239d049c, 0x156f150f, 0x351334b3, 0x3b623ce2, 0x275f085e
    .long 0x2a6e2a0e, 0x4a1249b2, 0x3b643ce4, 0x2b210c20, 0x2a6f2a0f, 0x4a1349b3, 0x3b663ce6, 0x2ee30fe2
    .long 0x3f6e3f0e, 0x5f125eb2, 0x3b683ce8, 0x60513a4, 0x3f6f3f0f, 0x5f135eb3, 0x3b6a3cea, 0x9c71766
    .long 0x546e540e, 0x741273b2, 0x3b6c3cec, 0xd891b28, 0x546f540f, 0x741373b3, 0x3b6e3cee, 0x114b1eea
    .long 0x696e690e, 0x891288b2, 0x3b703cf0, 0x150d22ac, 0x696f690f, 0x891388b3, 0x3b723cf2, 0x18cf266e
    .long 0x7e6e7e0e, 0xb1e0abe, 0x3b743cf4, 0x1c912a30, 0x7e6f7e0f, 0xb1f0abf, 0x3b763cf6, 0x20532df2
    .long 0x7a001a, 0x201e1fbe, 0x3b783cf8, 0x2415049d, 0x7b001b, 0x201f1fbf, 0x3b7a3cfa, 0x27d7085f
    .long 0x157a151a, 0x351e34be, 0x3b7c3cfc, 0x2b990c21, 0x157b151b, 0x351f34bf, 0x3b7e3cfe, 0x2f5b0fe3
    .long 0x2a782a18, 0x20041fa4, 0x3b803800, 0x4bb04b6, 0x2a792a19, 0x20051fa5, 0x3b823802, 0x87d0878
    .long 0x3f783f18, 0x350434a4, 0x3b843804, 0xc3f0c3a, 0x3f793f19, 0x350534a5, 0x3b863806, 0x10010ffc
    .long 0x54785418, 0x4a0449a4, 0x3b883808, 0x13c313be, 0x54795419, 0x4a0549a5, 0x3b8a380a, 0x17851780
    .long 0x69786918, 0x5f045ea4, 0x3b8c380c, 0x1b471b42, 0x69796919, 0x5f055ea5, 0x3b8e380e, 0x1f091f04
    .long 0x7e787e18, 0x740473a4, 0x3b903810, 0x22cb22c6, 0x7e797e19, 0x740573a5, 0x3b923812, 0x268d2688
    .long 0x840024, 0x890488a4, 0x3b943814, 0x2a4f2a4a, 0x850025, 0x890588a5, 0x3b963816, 0x2e112e0c
    .long 0x15841524, 0xb100ab0, 0x3b983818, 0x53304b7, 0x15851525, 0xb110ab1, 0x3b9a381a, 0x8f50879
    .long 0x2a842a24, 0x20101fb0, 0x3b9c381c, 0xcb70c3b, 0x2a852a25, 0x20111fb1, 0x3b9e381e, 0x10790ffd
    .long 0x3f843f24, 0x351034b0, 0x3ba03820, 0x143b13bf, 0x3f853f25, 0x351134b1, 0x3ba23822, 0x17fd1781
    .long 0x54845424, 0x4a1049b0, 0x3ba43824, 0x1bbf1b43, 0x54855425, 0x4a1149b1, 0x3ba63826, 0x1f811f05
    .long 0x69846924, 0x5f105eb0, 0x3ba83828, 0x234322c7, 0x69856925, 0x5f115eb1, 0x3baa382a, 0x27052689
    .long 0x7e847e24, 0x741073b0, 0x3bac382c, 0x2ac72a4b, 0x7e857e25, 0x741173b1, 0x3bae382e, 0x2e892e0d
    .long 0x900030, 0x891088b0, 0x3bb03830, 0x5ab04b8, 0x910031, 0x891188b1, 0x3bb23832, 0x96d087a
    .long 0x15901530, 0xb1c0abc, 0x3bb43834, 0xd2f0c3c, 0x15911531, 0xb1d0abd, 0x3bb63836, 0x10f10ffe
    .long 0x2a902a30, 0x201c1fbc, 0x3bb83838, 0x14b313c0, 0x2a912a31, 0x201d1fbd, 0x3bba383a, 0x18751782
    .long 0x3f903f30, 0x351c34bc, 0x3bbc383c, 0x1c371b44, 0x3f913f31, 0x351d34bd, 0x3bbe383e, 0x1ff91f06
    .long 0x2a7a2a1a, 0x20061fa6, 0x3bc03840, 0x23bb22c8, 0x2a7b2a1b, 0x20071fa7, 0x3bc23842, 0x277d268a
    .long 0x3f7a3f1a, 0x350634a6, 0x3bc43844, 0x2b3f2a4c, 0x3f7b3f1b, 0x350734a7, 0x3bc63846, 0x2f012e0e
    .long 0x547a541a, 0x4a0649a6, 0x3bc83848, 0x62304b9, 0x547b541b, 0x4a0749a7, 0x3bca384a, 0x9e5087b
    .long 0x697a691a, 0x5f065ea6, 0x3bcc384c, 0xda70c3d, 0x697b691b, 0x5f075ea7, 0x3bce384e, 0x11690fff
    .long 0x7e7a7e1a, 0x740673a6, 0x3bd03850, 0x152b13c1, 0x7e7b7e1b, 0x740773a7, 0x3bd23852, 0x18ed1783
    .long 0x860026, 0x890688a6, 0x3bd43854, 0x1caf1b45, 0x870027, 0x890788a7, 0x3bd63856, 0x20711f07
    .long 0x15861526, 0xb120ab2, 0x3bd83858, 0x243322c9, 0x15871527, 0xb130ab3, 0x3bda385a, 0x27f5268b
    .long 0x2a862a26, 0x20121fb2, 0x3bdc385c, 0x2bb72a4d, 0x2a872a27, 0x20131fb3, 0x3bde385e, 0x2f792e0f
    .long 0x3f863f26, 0x351234b2, 0x3be03860, 0x23bb04ba, 0x3f873f27, 0x351334b3, 0x3be23862, 0x277d087c
    .long 0x54865426, 0x4a1249b2, 0x3be43864, 0x2b3f0c3e, 0x54875427, 0x4a1349b3, 0x3be63866, 0x2f011000
    .long 0x69866926, 0x5f125eb2, 0x3be83868, 0x62313c2, 0x69876927, 0x5f135eb3, 0x3bea386a, 0x9e51784
    .long 0x7e867e26, 0x741273b2, 0x3bec386c, 0xda71b46, 0x7e877e27, 0x741373b3, 0x3bee386e, 0x11691f08
    .long 0x920032, 0x891288b2, 0x3bf03870, 0x152b22ca, 0x930033, 0x891388b3, 0x3bf23872, 0x18ed268c
    .long 0x15921532, 0xb1e0abe, 0x3bf43874, 0x1caf2a4e, 0x15931533, 0xb1f0abf, 0x3bf63876, 0x20712e10
    .long 0x2a922a32, 0x201e1fbe, 0x3bf83878, 0x243304bb, 0x2a932a33, 0x201f1fbf, 0x3bfa387a, 0x27f5087d
    .long 0x3f923f32, 0x351e34be, 0x3bfc387c, 0x2bb70c3f, 0x3f933f33, 0x351f34bf, 0x3bfe387e, 0x2f791001
    .long 0x54905430, 0x4a1c49bc, 0x3c004580, 0x4d904d4, 0x54915431, 0x4a1d49bd, 0x3c024582, 0x89b0896
    .long 0x69906930, 0x5f1c5ebc, 0x3c044584, 0xc5d0c58, 0x69916931, 0x5f1d5ebd, 0x3c064586, 0x101f101a
    .long 0x7e907e30, 0x741c73bc, 0x3c084588, 0x13e113dc, 0x7e917e31, 0x741d73bd, 0x3c0a458a, 0x17a3179e
    .long 0x9c003c, 0x891c88bc, 0x3c0c458c, 0x1b651b60, 0x9d003d, 0x891d88bd, 0x3c0e458e, 0x1f271f22
    .long 0x159c153c, 0x15480048, 0x3c104590, 0x22e922e4, 0x159d153d, 0x15490049, 0x3c124592, 0x26ab26a6
    .long 0x2a9c2a3c, 0x3f482a48, 0x3c144594, 0x2a6d2a68, 0x2a9d2a3d, 0x3f492a49, 0x3c164596, 0x2e2f2e2a
    .long 0x3f9c3f3c, 0x69485448, 0x3c184598, 0x55104d5, 0x3f9d3f3d, 0x69495449, 0x3c1a459a, 0x9130897
    .long 0x549c543c, 0x547e48, 0x3c1c459c, 0xcd50c59, 0x549d543d, 0x557e49, 0x3c1e459e, 0x1097101b
    .long 0x699c693c, 0x2a541554, 0x3c2045a0, 0x145913dd, 0x699d693d, 0x2a551555, 0x3c2245a2, 0x181b179f
    .long 0x7e9c7e3c, 0x54543f54, 0x3c2445a4, 0x1bdd1b61, 0x7e9d7e3d, 0x54553f55, 0x3c2645a6, 0x1f9f1f23
    .long 0xae00a80, 0x7e546954, 0x3c2845a8, 0x236122e5, 0xae10a81, 0x7e556955, 0x3c2a45aa, 0x272326a7
    .long 0x1fe01f80, 0x1fc80ac8, 0x3c2c45ac, 0x2ae52a69, 0x1fe11f81, 0x1fc90ac9, 0x3c2e45ae, 0x2ea72e2b
    .long 0x34e03480, 0x49c834c8, 0x3c3045b0, 0x5c904d6, 0x34e13481, 0x49c934c9, 0x3c3245b2, 0x98b0898
    .long 0x49e04980, 0x73c85ec8, 0x3c3445b4, 0xd4d0c5a, 0x49e14981, 0x73c95ec9, 0x3c3645b6, 0x110f101c
    .long 0x5ee05e80, 0xad488c8, 0x3c3845b8, 0x14d113de, 0x5ee15e81, 0xad588c9, 0x3c3a45ba, 0x189317a0
    .long 0x73e07380, 0x34d41fd4, 0x3c3c45bc, 0x1c551b62, 0x73e17381, 0x34d51fd5, 0x3c3e45be, 0x20171f24
    .long 0x54925432, 0x4a1e49be, 0x3c4045c0, 0x23d922e6, 0x54935433, 0x4a1f49bf, 0x3c4245c2, 0x279b26a8
    .long 0x69926932, 0x5f1e5ebe, 0x3c4445c4, 0x2b5d2a6a, 0x69936933, 0x5f1f5ebf, 0x3c4645c6, 0x2f1f2e2c
    .long 0x7e927e32, 0x741e73be, 0x3c4845c8, 0x64104d7, 0x7e937e33, 0x741f73bf, 0x3c4a45ca, 0xa030899
    .long 0x9e003e, 0x891e88be, 0x3c4c45cc, 0xdc50c5b, 0x9f003f, 0x891f88bf, 0x3c4e45ce, 0x1187101d
    .long 0x159e153e, 0x154a004a, 0x3c5045d0, 0x154913df, 0x159f153f, 0x154b004b, 0x3c5245d2, 0x190b17a1
    .long 0x2a9e2a3e, 0x3f4a2a4a, 0x3c5445d4, 0x1ccd1b63, 0x2a9f2a3f, 0x3f4b2a4b, 0x3c5645d6, 0x208f1f25
    .long 0x3f9e3f3e, 0x694a544a, 0x3c5845d8, 0x245122e7, 0x3f9f3f3f, 0x694b544b, 0x3c5a45da, 0x281326a9
    .long 0x549e543e, 0x567e4a, 0x3c5c45dc, 0x2bd52a6b, 0x549f543f, 0x577e4b, 0x3c5e45de, 0x2f972e2d
    .long 0x699e693e, 0x2a561556, 0x3c6045e0, 0x23d904d8, 0x699f693f, 0x2a571557, 0x3c6245e2, 0x279b089a
    .long 0x7e9e7e3e, 0x54563f56, 0x3c6445e4, 0x2b5d0c5c, 0x7e9f7e3f, 0x54573f57, 0x3c6645e6, 0x2f1f101e
    .long 0xae20a82, 0x7e566956, 0x3c6845e8, 0x64113e0, 0xae30a83, 0x7e576957, 0x3c6a45ea, 0xa0317a2
    .long 0x1fe21f82, 0x1fca0aca, 0x3c6c45ec, 0xdc51b64, 0x1fe31f83, 0x1fcb0acb, 0x3c6e45ee, 0x11871f26
    .long 0x34e23482, 0x49ca34ca, 0x3c7045f0, 0x154922e8, 0x34e33483, 0x49cb34cb, 0x3c7245f2, 0x190b26aa
    .long 0x49e24982, 0x73ca5eca, 0x3c7445f4, 0x1ccd2a6c, 0x49e34983, 0x73cb5ecb, 0x3c7645f6, 0x208f2e2e
    .long 0x5ee25e82, 0xad688ca, 0x3c7845f8, 0x245104d9, 0x5ee35e83, 0xad788cb, 0x3c7a45fa, 0x2813089b
    .long 0x73e27382, 0x34d61fd6, 0x3c7c45fc, 0x2bd50c5d, 0x73e37383, 0x34d71fd7, 0x3c7e45fe, 0x2f97101f
    .long 0x88e08880, 0x4a1c49bc, 0x3c004100, 0x4f704f2, 0x88e18881, 0x4a1d49bd, 0x3c024102, 0x8b908b4
    .long 0xaec0a8c, 0x5f1c5ebc, 0x3c044104, 0xc7b0c76, 0xaed0a8d, 0x5f1d5ebd, 0x3c064106, 0x103d1038
    .long 0x1fec1f8c, 0x741c73bc, 0x3c084108, 0x13ff13fa, 0x1fed1f8d, 0x741d73bd, 0x3c0a410a, 0x17c117bc
    .long 0x34ec348c, 0x891c88bc, 0x3c0c410c, 0x1b831b7e, 0x34ed348d, 0x891d88bd, 0x3c0e410e, 0x1f451f40
    .long 0x49ec498c, 0x15480048, 0x3c104110, 0x23072302, 0x49ed498d, 0x15490049, 0x3c124112, 0x26c926c4
    .long 0x5eec5e8c, 0x3f482a48, 0x3c144114, 0x2a8b2a86, 0x5eed5e8d, 0x3f492a49, 0x3c164116, 0x2e4d2e48
    .long 0x73ec738c, 0x69485448, 0x3c184118, 0x56f04f3, 0x73ed738d, 0x69495449, 0x3c1a411a, 0x93108b5
    .long 0x88ec888c, 0x547e48, 0x3c1c411c, 0xcf30c77, 0x88ed888d, 0x557e49, 0x3c1e411e, 0x10b51039
    .long 0xaf80a98, 0x2a541554, 0x3c204120, 0x147713fb, 0xaf90a99, 0x2a551555, 0x3c224122, 0x183917bd
    .long 0x1ff81f98, 0x54543f54, 0x3c244124, 0x1bfb1b7f, 0x1ff91f99, 0x54553f55, 0x3c264126, 0x1fbd1f41
    .long 0x34f83498, 0x7e546954, 0x3c284128, 0x237f2303, 0x34f93499, 0x7e556955, 0x3c2a412a, 0x274126c5
    .long 0x49f84998, 0x1fc80ac8, 0x3c2c412c, 0x2b032a87, 0x49f94999, 0x1fc90ac9, 0x3c2e412e, 0x2ec52e49
    .long 0x5ef85e98, 0x49c834c8, 0x3c304130, 0x5e704f4, 0x5ef95e99, 0x49c934c9, 0x3c324132, 0x9a908b6
    .long 0x73f87398, 0x73c85ec8, 0x3c344134, 0xd6b0c78, 0x73f97399, 0x73c95ec9, 0x3c364136, 0x112d103a
    .long 0x88f88898, 0xad488c8, 0x3c384138, 0x14ef13fc, 0x88f98899, 0xad588c9, 0x3c3a413a, 0x18b117be
    .long 0xb040aa4, 0x34d41fd4, 0x3c3c413c, 0x1c731b80, 0xb050aa5, 0x34d51fd5, 0x3c3e413e, 0x20351f42
    .long 0x88e28882, 0x4a1e49be, 0x3c404140, 0x23f72304, 0x88e38883, 0x4a1f49bf, 0x3c424142, 0x27b926c6
    .long 0xaee0a8e, 0x5f1e5ebe, 0x3c444144, 0x2b7b2a88, 0xaef0a8f, 0x5f1f5ebf, 0x3c464146, 0x2f3d2e4a
    .long 0x1fee1f8e, 0x741e73be, 0x3c484148, 0x65f04f5, 0x1fef1f8f, 0x741f73bf, 0x3c4a414a, 0xa2108b7
    .long 0x34ee348e, 0x891e88be, 0x3c4c414c, 0xde30c79, 0x34ef348f, 0x891f88bf, 0x3c4e414e, 0x11a5103b
    .long 0x49ee498e, 0x154a004a, 0x3c504150, 0x156713fd, 0x49ef498f, 0x154b004b, 0x3c524152, 0x192917bf
    .long 0x5eee5e8e, 0x3f4a2a4a, 0x3c544154, 0x1ceb1b81, 0x5eef5e8f, 0x3f4b2a4b, 0x3c564156, 0x20ad1f43
    .long 0x73ee738e, 0x694a544a, 0x3c584158, 0x246f2305, 0x73ef738f, 0x694b544b, 0x3c5a415a, 0x283126c7
    .long 0x88ee888e, 0x567e4a, 0x3c5c415c, 0x2bf32a89, 0x88ef888f, 0x577e4b, 0x3c5e415e, 0x2fb52e4b
    .long 0xafa0a9a, 0x2a561556, 0x3c604160, 0x23f704f6, 0xafb0a9b, 0x2a571557, 0x3c624162, 0x27b908b8
    .long 0x1ffa1f9a, 0x54563f56, 0x3c644164, 0x2b7b0c7a, 0x1ffb1f9b, 0x54573f57, 0x3c664166, 0x2f3d103c
    .long 0x34fa349a, 0x7e566956, 0x3c684168, 0x65f13fe, 0x34fb349b, 0x7e576957, 0x3c6a416a, 0xa2117c0
    .long 0x49fa499a, 0x1fca0aca, 0x3c6c416c, 0xde31b82, 0x49fb499b, 0x1fcb0acb, 0x3c6e416e, 0x11a51f44
    .long 0x5efa5e9a, 0x49ca34ca, 0x3c704170, 0x15672306, 0x5efb5e9b, 0x49cb34cb, 0x3c724172, 0x192926c8
    .long 0x73fa739a, 0x73ca5eca, 0x3c744174, 0x1ceb2a8a, 0x73fb739b, 0x73cb5ecb, 0x3c764176, 0x20ad2e4c
    .long 0x88fa889a, 0xad688ca, 0x3c784178, 0x246f04f7, 0x88fb889b, 0xad788cb, 0x3c7a417a, 0x283108b9
    .long 0xb060aa6, 0x34d61fd6, 0x3c7c417c, 0x2bf30c7b, 0xb070aa7, 0x34d71fd7, 0x3c7e417e, 0x2fb5103d
    .long 0x3f80, 0x0, 0x0, 0x0, 0x3f800000, 0x0, 0x0, 0x0
    .long 0x0, 0x3f80, 0x0, 0x0, 0x0, 0x3f800000, 0x0, 0x0
    .long 0x0, 0x0, 0x3f80, 0x0, 0x0, 0x0, 0x3f800000, 0x0
    .long 0x0, 0x0, 0x0, 0x3f80, 0x0, 0x0, 0x0, 0x3f800000
    .long 0x0, 0x0, 0x0, 0x0, 0x0, 0x0, 0x0, 0x0
    .long 0x0, 0x0, 0x0, 0x0, 0x0, 0x0, 0x0, 0x0
    .long 0x0, 0x0, 0x0, 0x0, 0x0, 0x0, 0x0, 0x0
    .long 0x0, 0x0, 0x0, 0x0, 0x0, 0x0, 0x0, 0x0
    .long 0x0, 0x0, 0x0, 0x0, 0x0, 0x0, 0x0, 0x0
    .long 0x0, 0x0, 0x0, 0x0, 0x0, 0x0, 0x0, 0x0
    .long 0x0, 0x0, 0x0, 0x0, 0x0, 0x0, 0x0, 0x0
    .long 0x0, 0x0, 0x0, 0x0, 0x0, 0x0, 0x0, 0x0
    .long 0x0, 0x0, 0x0, 0x0, 0x0, 0x0, 0x0, 0x0
    .long 0x0, 0x0, 0x0, 0x0, 0x0, 0x0, 0x0, 0x0
    .long 0x0, 0x0, 0x0, 0x0, 0x0, 0x0, 0x0, 0x0
    .long 0x0, 0x0, 0x0, 0x0, 0x0, 0x0, 0x0, 0x0
    .long 0x0, 0x0, 0x0, 0x0, 0x0, 0x0, 0x0, 0x0
    .long 0x0, 0x0, 0x0, 0x0, 0x0, 0x0, 0x0, 0x0
    .long 0x0, 0x0, 0x0, 0x0, 0x0, 0x0, 0x0, 0x0
    .long 0x0, 0x0, 0x0, 0x0, 0x0, 0x0, 0x0, 0x0
    .long 0x3f80, 0x0, 0x0, 0x0, 0x3f800000, 0x0, 0x0, 0x0
    .long 0x0, 0x3f80, 0x0, 0x0, 0x0, 0x3f800000, 0x0, 0x0
    .long 0x0, 0x0, 0x3f80, 0x0, 0x0, 0x0, 0x3f800000, 0x0
    .long 0x0, 0x0, 0x0, 0x3f80, 0x0, 0x0, 0x0, 0x3f800000
    .long 0x0, 0x0, 0x0, 0x0, 0x0, 0x0, 0x0, 0x0
    .long 0x0, 0x0, 0x0, 0x0, 0x0, 0x0, 0x0, 0x0
    .long 0x0, 0x0, 0x0, 0x0, 0x0, 0x0, 0x0, 0x0
    .long 0x0, 0x0, 0x0, 0x0, 0x0, 0x0, 0x0, 0x0
    .long 0x0, 0x0, 0x0, 0x0, 0x0, 0x0, 0x0, 0x0
    .long 0x0, 0x0, 0x0, 0x0, 0x0, 0x0, 0x0, 0x0
    .long 0x0, 0x0, 0x0, 0x0, 0x0, 0x0, 0x0, 0x0
    .long 0x0, 0x0, 0x0, 0x0, 0x0, 0x0, 0x0, 0x0
    .long 0x0, 0x0, 0x0, 0x0, 0x0, 0x0, 0x0, 0x0
    .long 0x0, 0x0, 0x0, 0x0, 0x0, 0x0, 0x0, 0x0
    .long 0x0, 0x0, 0x0, 0x0, 0x0, 0x0, 0x0, 0x0
    .long 0x0, 0x0, 0x0, 0x0, 0x0, 0x0, 0x0, 0x0
    .long 0x0, 0x0, 0x0, 0x0, 0x0, 0x0, 0x0, 0x0
    .long 0x0, 0x0, 0x0, 0x0, 0x0, 0x0, 0x0, 0x0
    .long 0x0, 0x0, 0x0, 0x0, 0x0, 0x0, 0x0, 0x0
    .long 0x0, 0x0, 0x0, 0x0, 0x0, 0x0, 0x0, 0x0
    .long 0x3f80, 0x0, 0x0, 0x0, 0x3f800000, 0x0, 0x0, 0x0
    .long 0x0, 0x3f80, 0x0, 0x0, 0x0, 0x3f800000, 0x0, 0x0
    .long 0x0, 0x0, 0x3f80, 0x0, 0x0, 0x0, 0x3f800000, 0x0
    .long 0x0, 0x0, 0x0, 0x3f80, 0x0, 0x0, 0x0, 0x3f800000
    .long 0x0, 0x0, 0x0, 0x0, 0x0, 0x0, 0x0, 0x0
    .long 0x0, 0x0, 0x0, 0x0, 0x0, 0x0, 0x0, 0x0
    .long 0x0, 0x0, 0x0, 0x0, 0x0, 0x0, 0x0, 0x0
    .long 0x0, 0x0, 0x0, 0x0, 0x0, 0x0, 0x0, 0x0
    .long 0x0, 0x0, 0x0, 0x0, 0x0, 0x0, 0x0, 0x0
    .long 0x0, 0x0, 0x0, 0x0, 0x0, 0x0, 0x0, 0x0
    .long 0x0, 0x0, 0x0, 0x0, 0x0, 0x0, 0x0, 0x0
    .long 0x0, 0x0, 0x0, 0x0, 0x0, 0x0, 0x0, 0x0
    .long 0x0, 0x0, 0x0, 0x0, 0x0, 0x0, 0x0, 0x0
    .long 0x0, 0x0, 0x0, 0x0, 0x0, 0x0, 0x0, 0x0
    .long 0x0, 0x0, 0x0, 0x0, 0x0, 0x0, 0x0, 0x0
    .long 0x0, 0x0, 0x0, 0x0, 0x0, 0x0, 0x0, 0x0
    .long 0x0, 0x0, 0x0, 0x0, 0x0, 0x0, 0x0, 0x0
    .long 0x0, 0x0, 0x0, 0x0, 0x0, 0x0, 0x0, 0x0
    .long 0x0, 0x0, 0x0, 0x0, 0x0, 0x0, 0x0, 0x0
    .long 0x0, 0x0, 0x0, 0x0, 0x0, 0x0, 0x0, 0x0
    .long 0x3f80, 0x0, 0x0, 0x0, 0x3f800000, 0x0, 0x0, 0x0
    .long 0x0, 0x3f80, 0x0, 0x0, 0x0, 0x3f800000, 0x0, 0x0
    .long 0x0, 0x0, 0x3f80, 0x0, 0x0, 0x0, 0x3f800000, 0x0
    .long 0x0, 0x0, 0x0, 0x3f80, 0x0, 0x0, 0x0, 0x3f800000
    .long 0x3f80, 0x0, 0x0, 0x0, 0x3f800000, 0x0, 0x0, 0x0
    .long 0x0, 0x3f80, 0x0, 0x0, 0x0, 0x3f800000, 0x0, 0x0
    .long 0x0, 0x0, 0x3f80, 0x0, 0x0, 0x0, 0x3f800000, 0x0
    .long 0x0, 0x0, 0x0, 0x3f80, 0x0, 0x0, 0x0, 0x3f800000
    .long 0x0, 0x0, 0x0, 0x0, 0x0, 0x0, 0x0, 0x0
    .long 0x0, 0x0, 0x0, 0x0, 0x0, 0x0, 0x0, 0x0
    .long 0x0, 0x0, 0x0, 0x0, 0x0, 0x0, 0x0, 0x0
    .long 0x0, 0x0, 0x0, 0x0, 0x0, 0x0, 0x0, 0x0
    .long 0x0, 0x0, 0x0, 0x0, 0x0, 0x0, 0x0, 0x0
    .long 0x0, 0x0, 0x0, 0x0, 0x0, 0x0, 0x0, 0x0
    .long 0x0, 0x0, 0x0, 0x0, 0x0, 0x0, 0x0, 0x0
    .long 0x0, 0x0, 0x0, 0x0, 0x0, 0x0, 0x0, 0x0
    .long 0x0, 0x0, 0x0, 0x0, 0x0, 0x0, 0x0, 0x0
    .long 0x0, 0x0, 0x0, 0x0, 0x0, 0x0, 0x0, 0x0
    .long 0x0, 0x0, 0x0, 0x0, 0x0, 0x0, 0x0, 0x0
    .long 0x0, 0x0, 0x0, 0x0, 0x0, 0x0, 0x0, 0x0
    .long 0x0, 0x0, 0x0, 0x0, 0x0, 0x0, 0x0, 0x0
    .long 0x0, 0x0, 0x0, 0x0, 0x0, 0x0, 0x0, 0x0
    .long 0x0, 0x0, 0x0, 0x0, 0x0, 0x0, 0x0, 0x0
    .long 0x0, 0x0, 0x0, 0x0, 0x0, 0x0, 0x0, 0x0
    .long 0x3f80, 0x0, 0x0, 0x0, 0x3f800000, 0x0, 0x0, 0x0
    .long 0x0, 0x3f80, 0x0, 0x0, 0x0, 0x3f800000, 0x0, 0x0
    .long 0x0, 0x0, 0x3f80, 0x0, 0x0, 0x0, 0x3f800000, 0x0
    .long 0x0, 0x0, 0x0, 0x3f80, 0x0, 0x0, 0x0, 0x3f800000
    .long 0x0, 0x0, 0x0, 0x0, 0x0, 0x0, 0x0, 0x0
    .long 0x0, 0x0, 0x0, 0x0, 0x0, 0x0, 0x0, 0x0
    .long 0x0, 0x0, 0x0, 0x0, 0x0, 0x0, 0x0, 0x0
    .long 0x0, 0x0, 0x0, 0x0, 0x0, 0x0, 0x0, 0x0
    .long 0x0, 0x0, 0x0, 0x0, 0x0, 0x0, 0x0, 0x0
    .long 0x0, 0x0, 0x0, 0x0, 0x0, 0x0, 0x0, 0x0
    .long 0x0, 0x0, 0x0, 0x0, 0x0, 0x0, 0x0, 0x0
    .long 0x0, 0x0, 0x0, 0x0, 0x0, 0x0, 0x0, 0x0
L_tab_end:
.section .rodata,"a"
.p2align 6
.amdhsa_kernel standalone__convnext_block__vision_kernel
  .amdhsa_next_free_vgpr 512
  .amdhsa_next_free_sgpr 102
  .amdhsa_accum_offset 256
  .amdhsa_group_segment_fixed_size 0
  .amdhsa_kernarg_size 56
  .amdhsa_user_sgpr_count 2
  .amdhsa_user_sgpr_kernarg_segment_ptr 1
  .amdhsa_system_sgpr_workgroup_id_x 1
.end_amdhsa_kernel
```
